```python
import torch

def _softmax(x, axis=-1):
    return torch.softmax(x, dim=axis)

def _gelu(x):
    return torch.nn.functional.gelu(x, approximate='tanh')

def _silu(x):
    return torch.nn.functional.silu(x)

def _sigmoid(x):
    return torch.sigmoid(x)

def _layernorm(x, axis=-1, eps=1e-05):
    m = x.mean(dim=axis, keepdim=True)
    v = x.var(dim=axis, keepdim=True, unbiased=False)
    return (x - m) / torch.sqrt(v + eps)

def _scatter_add(tgt, idx, src, axis=0):
    return tgt.clone().index_add_(axis, idx, src)

def _segment_sum(src, seg, n):
    out = torch.zeros((n,) + src.shape[1:], dtype=src.dtype)
    return out.index_add_(0, seg, src)

def _pad(x, pw):
    flat = tuple((v for pair in reversed(pw) for v in pair))
    return torch.nn.functional.pad(x, flat)
kernel_name = 'sequential_preLN__grouped_kv_mqa__mixer_gmlp__prompt'

def setup_inputs():

    _w = lambda a: (lambda t: t.to(torch.bfloat16) if t.is_floating_point() else t)(torch.as_tensor(a))

    def _A_setup():
        B, S, D, H = (1, 2048, 512, 32)
        Dh = D // H
        return {'x': _w((lambda *s: torch.randn(*s, dtype=torch.bfloat16) * 0.05)(B, S, D)), 'wq': _w((lambda *s: torch.randn(*s, dtype=torch.bfloat16) * 0.05)(D, H * Dh)), 'wk': _w((lambda *s: torch.randn(*s, dtype=torch.bfloat16) * 0.05)(D, Dh)), 'wv': _w((lambda *s: torch.randn(*s, dtype=torch.bfloat16) * 0.05)(D, Dh)), 'wo': _w((lambda *s: torch.randn(*s, dtype=torch.bfloat16) * 0.05)(H * Dh, D))}
    _A_in = _A_setup()

    def _B_setup():
        B, S, D, F = (1, 2048, 512, 1376)
        Fh = F // 2
        return {'x': _w((lambda *s: torch.randn(*s, dtype=torch.bfloat16) * 0.05)(B, S, D)), 'w_in': _w((lambda *s: torch.randn(*s, dtype=torch.bfloat16) * 0.4)(D, 2 * Fh)), 'w_sp': _w(0.01 * (lambda *s: torch.randn(*s, dtype=torch.bfloat16) * 0.4)(S, S)), 'b_sp': _w(1.0 + 0.01 * (lambda *s: torch.randn(*s, dtype=torch.bfloat16) * 0.05)(S)), 'w_out': _w((lambda *s: torch.randn(*s, dtype=torch.bfloat16) * 0.05)(Fh, D))}
    _B_in = _B_setup()
    return {'A_x': _A_in['x'], 'A_wq': _A_in['wq'], 'A_wk': _A_in['wk'], 'A_wv': _A_in['wv'], 'A_wo': _A_in['wo'], 'B_x': _B_in['x'], 'B_w_in': _B_in['w_in'], 'B_w_sp': _B_in['w_sp'], 'B_b_sp': _B_in['b_sp'], 'B_w_out': _B_in['w_out']}

def reference(A_x, A_wq, A_wk, A_wv, A_wo, B_x, B_w_in, B_w_sp, B_b_sp, B_w_out):

    def _A_ref(x, wq, wk, wv, wo):
        B, S, D = x.shape
        H = 32
        Dh = D // H
        q = (lambda x, *d: x.permute(*d))((x @ wq).reshape(B, S, H, Dh), 0, 2, 1, 3)
        k = x @ wk
        v = x @ wv
        scores = torch.einsum('bhqd,bkd->bhqk', q, k) * Dh ** (-0.5)
        p = _softmax(scores, axis=-1)
        o = torch.einsum('bhqk,bkd->bhqd', p, v)
        return (lambda x, *d: x.permute(*d))(o, 0, 2, 1, 3).reshape(B, S, H * Dh) @ wo

    def _B_ref(x, w_in, w_sp, b_sp, w_out):
        B, S, D = x.shape
        F = w_in.shape[-1]
        Fh = F // 2
        z = _gelu(torch.einsum('bsd,df->bsf', x, w_in))
        z1 = z[..., :Fh].clone()
        z2 = _layernorm(z[..., Fh:], axis=-1)
        g = torch.einsum('ts,bsf->btf', w_sp, z2) + b_sp[None, :, None]
        return torch.einsum('bsf,fd->bsd', z1 * g, w_out)
    x = A_x
    h = x + _A_ref(_layernorm(x, axis=-1), A_wq, A_wk, A_wv, A_wo)
    h2 = h + _B_ref(_layernorm(h, axis=-1), B_w_in, B_w_sp, B_b_sp, B_w_out)
    return h2
```

```asm
; @launch grid=(256,1,1) block=(1024,1,1) lds=163840
.amdgcn_target "amdgcn-amd-amdhsa--gfx950"
.text
.globl sequential_preLN__grouped_kv_mqa__mixer_gmlp__prompt_kernel
.p2align 8
.type sequential_preLN__grouped_kv_mqa__mixer_gmlp__prompt_kernel,@function
sequential_preLN__grouped_kv_mqa__mixer_gmlp__prompt_kernel:
    s_cmp_ge_u32 s2, 256
    s_cbranch_scc1 L_sequential_preLN__grouped_kv_mqa__mixer_gmlp__prompt_kernel_end
    v_and_b32 v1, 63, v0
    v_lshrrev_b32 v2, 6, v0
    s_nop 0
    v_readfirstlane_b32 s28, v2
    s_load_dwordx8 s[4:11], s[0:1], 0
    s_load_dwordx4 s[12:15], s[0:1], 88
    s_and_b32 s29, s2, 7
    s_lshr_b32 s30, s2, 3
    s_lshl_b32 s29, s29, 2
    s_lshr_b32 s31, s30, 3
    s_add_u32 s29, s29, s31
    s_and_b32 s30, s30, 7
    s_and_b32 s3, s28, 3
    s_and_b32 s32, s28, 1
    s_mov_b32 s56, s29
    s_mov_b32 s57, s30
    s_lshl_b32 s46, s31, 1
    s_add_u32 s46, s46, s30
    s_and_b32 s46, s46, 7
    s_lshr_b32 s33, s3, 1
    s_mov_b32 s62, 0
    s_mov_b32 s20, 0
    s_mov_b32 s21, 0
    s_mov_b32 s22, 0
    s_mov_b32 s23, 0x00020000
    v_mov_b32 v108, 0
    v_mov_b32 v109, 0
    v_mov_b32 v113, 0
    v_lshlrev_b32 v2, 4, v1
    v_lshrrev_b32 v8, 4, v1
    v_lshrrev_b32 v9, 5, v1
    v_lshrrev_b32 v10, 2, v1
    v_and_b32 v10, 3, v10
    v_and_b32 v11, 3, v1
    s_cmp_ge_u32 s28, 12
    s_cbranch_scc1 L_p0_st
    s_cmp_ge_u32 s28, 8
    s_cbranch_scc1 L_p0_q
    s_cmp_eq_u32 s28, 2
    s_cbranch_scc1 L_p0_kv
    s_cmp_eq_u32 s28, 3
    s_cbranch_scc1 L_p0_n
    s_cmp_lt_u32 s28, 2
    s_cbranch_scc1 L_p0_pack
    s_lshl_b32 s34, s29, 6
    s_lshl_b32 s35, s3, 4
    s_add_u32 s34, s34, s35
    v_lshrrev_b32 v12, 3, v1
    v_add_u32 v6, s34, v12
    v_lshlrev_b32 v6, 10, v6
    v_and_b32 v13, 7, v1
    v_xor_b32 v14, v13, v8
    v_lshl_add_u32 v6, v14, 4, v6
    v_xor_b32 v7, 64, v6
    v_add_u32 v7, 8192, v7
    s_lshl_b32 s36, s30, 7
    s_lshl_b32 s37, s3, 11
    s_mov_b32 s45, s46
    v_lshrrev_b32 v12, 3, v1
    v_and_b32 v13, 7, v1
    v_add_u32 v4, s35, v12
    v_lshlrev_b32 v4, 10, v4
    v_and_b32 v14, 1, v8
    v_lshlrev_b32 v14, 2, v14
    v_xor_b32 v14, v13, v14
    v_lshl_add_u32 v4, v14, 4, v4
    v_add_u32 v4, s36, v4
    v_add_u32 v5, 8192, v4
    s_waitcnt lgkmcnt(0)
    s_mov_b32 s16, s4
    s_mov_b32 s17, s5
    s_mov_b32 s18, 0x200000
    s_mov_b32 s19, 0x00020000
    s_mov_b32 s20, s6
    s_mov_b32 s21, s7
    s_mov_b32 s22, 0x80000
    s_mov_b32 s23, 0x00020000
    s_mov_b32 s24, s14
    s_mov_b32 s25, s15
    s_mov_b32 s26, 0x1700000
    s_mov_b32 s27, 0x00020000
    s_add_u32 m0, s37, 0
    s_lshl_b32 s38, s46, 7
    s_add_u32 s46, s46, 1
    buffer_load_dwordx4 v6, s[16:19], s38 offen lds
    s_add_u32 m0, s37, 1024
    s_and_b32 s46, s46, 7
    buffer_load_dwordx4 v7, s[16:19], s38 offen lds
    s_add_u32 m0, s37, 8192
    s_lshl_b32 s38, s46, 7
    s_add_u32 s46, s46, 1
    buffer_load_dwordx4 v6, s[16:19], s38 offen lds
    s_add_u32 m0, s37, 9216
    s_and_b32 s46, s46, 7
    buffer_load_dwordx4 v7, s[16:19], s38 offen lds
    s_add_u32 m0, s37, 16384
    s_lshl_b32 s38, s46, 7
    s_add_u32 s46, s46, 1
    buffer_load_dwordx4 v6, s[16:19], s38 offen lds
    s_add_u32 m0, s37, 17408
    s_and_b32 s46, s46, 7
    buffer_load_dwordx4 v7, s[16:19], s38 offen lds
    s_add_u32 m0, s37, 24576
    s_lshl_b32 s38, s46, 7
    s_add_u32 s46, s46, 1
    buffer_load_dwordx4 v6, s[16:19], s38 offen lds
    s_add_u32 m0, s37, 25600
    s_and_b32 s46, s46, 7
    buffer_load_dwordx4 v7, s[16:19], s38 offen lds
    s_add_u32 m0, s37, 32768
    s_lshl_b32 s38, s46, 7
    s_add_u32 s46, s46, 1
    buffer_load_dwordx4 v6, s[16:19], s38 offen lds
    s_add_u32 m0, s37, 33792
    s_and_b32 s46, s46, 7
    buffer_load_dwordx4 v7, s[16:19], s38 offen lds
    s_add_u32 m0, s37, 40960
    s_lshl_b32 s38, s46, 7
    s_add_u32 s46, s46, 1
    buffer_load_dwordx4 v6, s[16:19], s38 offen lds
    s_add_u32 m0, s37, 41984
    s_and_b32 s46, s46, 7
    buffer_load_dwordx4 v7, s[16:19], s38 offen lds
    s_waitcnt vmcnt(8)
    s_barrier
    s_add_u32 m0, s37, 49152
    s_lshl_b32 s38, s46, 7
    s_add_u32 s46, s46, 1
    buffer_load_dwordx4 v6, s[16:19], s38 offen lds
    s_add_u32 m0, s37, 50176
    s_and_b32 s46, s46, 7
    buffer_load_dwordx4 v7, s[16:19], s38 offen lds
    s_add_u32 m0, s37, 57344
    s_lshl_b32 s38, s46, 7
    s_add_u32 s46, s46, 1
    buffer_load_dwordx4 v6, s[16:19], s38 offen lds
    s_add_u32 m0, s37, 58368
    s_and_b32 s46, s46, 7
    buffer_load_dwordx4 v7, s[16:19], s38 offen lds
    s_add_u32 m0, s37, 65536
    s_lshl_b32 s38, s45, 16
    s_add_u32 s45, s45, 1
    buffer_load_dwordx4 v4, s[20:23], s38 offen lds
    s_add_u32 m0, s37, 66560
    s_and_b32 s45, s45, 7
    buffer_load_dwordx4 v5, s[20:23], s38 offen lds
    s_add_u32 m0, s37, 73728
    s_lshl_b32 s38, s45, 16
    s_add_u32 s45, s45, 1
    buffer_load_dwordx4 v4, s[20:23], s38 offen lds
    s_add_u32 m0, s37, 74752
    s_and_b32 s45, s45, 7
    buffer_load_dwordx4 v5, s[20:23], s38 offen lds
    s_waitcnt vmcnt(12)
    s_barrier
    s_add_u32 m0, s37, 81920
    s_lshl_b32 s38, s45, 16
    s_add_u32 s45, s45, 1
    buffer_load_dwordx4 v4, s[20:23], s38 offen lds
    s_add_u32 m0, s37, 82944
    s_and_b32 s45, s45, 7
    buffer_load_dwordx4 v5, s[20:23], s38 offen lds
    s_add_u32 m0, s37, 90112
    s_lshl_b32 s38, s45, 16
    s_add_u32 s45, s45, 1
    buffer_load_dwordx4 v4, s[20:23], s38 offen lds
    s_add_u32 m0, s37, 91136
    s_and_b32 s45, s45, 7
    buffer_load_dwordx4 v5, s[20:23], s38 offen lds
    s_add_u32 m0, s37, 98304
    s_lshl_b32 s38, s45, 16
    s_add_u32 s45, s45, 1
    buffer_load_dwordx4 v4, s[20:23], s38 offen lds
    s_add_u32 m0, s37, 99328
    s_and_b32 s45, s45, 7
    buffer_load_dwordx4 v5, s[20:23], s38 offen lds
    s_waitcnt vmcnt(14)
    s_barrier
    s_add_u32 m0, s37, 106496
    s_lshl_b32 s38, s45, 16
    s_add_u32 s45, s45, 1
    buffer_load_dwordx4 v4, s[20:23], s38 offen lds
    s_add_u32 m0, s37, 107520
    s_and_b32 s45, s45, 7
    buffer_load_dwordx4 v5, s[20:23], s38 offen lds
    s_add_u32 m0, s37, 114688
    s_lshl_b32 s38, s45, 16
    s_add_u32 s45, s45, 1
    buffer_load_dwordx4 v4, s[20:23], s38 offen lds
    s_add_u32 m0, s37, 115712
    s_and_b32 s45, s45, 7
    buffer_load_dwordx4 v5, s[20:23], s38 offen lds
    s_add_u32 m0, s37, 122880
    s_lshl_b32 s38, s45, 16
    s_add_u32 s45, s45, 1
    buffer_load_dwordx4 v4, s[20:23], s38 offen lds
    s_add_u32 m0, s37, 123904
    s_and_b32 s45, s45, 7
    buffer_load_dwordx4 v5, s[20:23], s38 offen lds
    s_waitcnt vmcnt(16)
    s_barrier
    s_barrier
    s_waitcnt vmcnt(12)
    s_barrier
    s_waitcnt vmcnt(8)
    s_barrier
    s_waitcnt vmcnt(4)
    s_barrier
    s_waitcnt vmcnt(0)
    s_barrier
    s_branch L_att
L_p0_q:
    v_mov_b32 v64, 0x3f803f80
    v_mov_b32 v65, 0x3f803f80
    v_mov_b32 v66, 0x3f803f80
    v_mov_b32 v67, 0x3f803f80
    v_lshl_add_u32 v6, v9, 3, v10
    v_lshlrev_b32 v6, 7, v6
    v_lshrrev_b32 v12, 1, v10
    v_xor_b32 v12, s33, v12
    v_lshl_add_u32 v6, v12, 6, v6
    v_and_b32 v12, 1, v8
    v_lshl_add_u32 v6, v12, 5, v6
    v_lshl_add_u32 v6, v11, 3, v6
    v_add_u32 v6, 65536, v6
    v_and_b32 v12, 31, v1
    s_lshl_b32 s40, s32, 5
    v_add_u32 v12, s40, v12
    v_lshlrev_b32 v76, 3, v12
    v_add_u32 v76, 147456, v76
    v_lshlrev_b32 v77, 4, v9
    s_lshl_b32 s41, s3, 7
    s_add_u32 s41, s41, 148480
    v_add_u32 v77, s41, v77
    v_xor_b32 v78, 128, v77
    v_lshrrev_b32 v13, 1, v12
    v_and_b32 v13, 7, v13
    v_lshlrev_b32 v12, 7, v12
    v_add_u32 v14, 0, v9
    v_xor_b32 v14, v14, v13
    v_lshl_add_u32 v72, v14, 4, v12
    v_add_u32 v14, 2, v9
    v_xor_b32 v14, v14, v13
    v_lshl_add_u32 v73, v14, 4, v12
    v_add_u32 v14, 4, v9
    v_xor_b32 v14, v14, v13
    v_lshl_add_u32 v74, v14, 4, v12
    v_add_u32 v14, 6, v9
    v_xor_b32 v14, v14, v13
    v_lshl_add_u32 v75, v14, 4, v12
    v_mov_b32 v32, 0
    v_mov_b32 v33, 0
    v_mov_b32 v34, 0
    v_mov_b32 v35, 0
    v_mov_b32 v36, 0
    v_mov_b32 v37, 0
    v_mov_b32 v38, 0
    v_mov_b32 v39, 0
    v_mov_b32 v40, 0
    v_mov_b32 v41, 0
    v_mov_b32 v42, 0
    v_mov_b32 v43, 0
    v_mov_b32 v44, 0
    v_mov_b32 v45, 0
    v_mov_b32 v46, 0
    v_mov_b32 v47, 0
    v_mov_b32 v48, 0
    v_mov_b32 v49, 0
    v_mov_b32 v50, 0
    v_mov_b32 v51, 0
    v_mov_b32 v52, 0
    v_mov_b32 v53, 0
    v_mov_b32 v54, 0
    v_mov_b32 v55, 0
    v_mov_b32 v56, 0
    v_mov_b32 v57, 0
    v_mov_b32 v58, 0
    v_mov_b32 v59, 0
    v_mov_b32 v60, 0
    v_mov_b32 v61, 0
    v_mov_b32 v62, 0
    v_mov_b32 v63, 0
    s_waitcnt lgkmcnt(0)
    s_mov_b32 s24, s14
    s_mov_b32 s25, s15
    s_mov_b32 s26, 0x1700000
    s_mov_b32 s27, 0x00020000
    s_barrier
    s_barrier
    s_barrier
    s_barrier
    s_barrier
    s_cmp_eq_u32 s32, 0
    s_cbranch_scc0 L_p0_qcs
    s_barrier
    ds_read_b64_tr_b16 v[80:81], v6 offset:0
    ds_read_b64_tr_b16 v[82:83], v6 offset:512
    ds_read_b128 v[84:87], v72 offset:0
    ds_read_b64_tr_b16 v[88:89], v6 offset:2048
    ds_read_b64_tr_b16 v[90:91], v6 offset:2560
    ds_read_b128 v[92:95], v73 offset:0
    ds_read_b64_tr_b16 v[96:97], v6 offset:4096
    ds_read_b64_tr_b16 v[98:99], v6 offset:4608
    ds_read_b128 v[100:103], v74 offset:0
    ds_read_b64_tr_b16 v[104:105], v6 offset:6144
    ds_read_b64_tr_b16 v[106:107], v6 offset:6656
    ds_read_b128 v[108:111], v75 offset:0
    s_waitcnt lgkmcnt(9)
    v_mfma_f32_32x32x16_bf16 v[32:47], v[80:83], v[84:87], v[32:47]
    v_mfma_f32_32x32x16_bf16 v[48:63], v[80:83], v[64:67], v[48:63]
    s_waitcnt lgkmcnt(6)
    v_mfma_f32_32x32x16_bf16 v[32:47], v[88:91], v[92:95], v[32:47]
    s_waitcnt lgkmcnt(3)
    v_mfma_f32_32x32x16_bf16 v[32:47], v[96:99], v[100:103], v[32:47]
    v_mfma_f32_32x32x16_bf16 v[48:63], v[96:99], v[64:67], v[48:63]
    s_waitcnt lgkmcnt(0)
    ds_read_b64_tr_b16 v[112:113], v6 offset:8192
    ds_read_b64_tr_b16 v[114:115], v6 offset:8704
    ds_read_b128 v[116:119], v72 offset:8192
    ds_read_b64_tr_b16 v[120:121], v6 offset:10240
    ds_read_b64_tr_b16 v[122:123], v6 offset:10752
    ds_read_b128 v[124:127], v73 offset:8192
    ds_read_b64_tr_b16 v[16:17], v6 offset:12288
    ds_read_b64_tr_b16 v[18:19], v6 offset:12800
    ds_read_b128 v[20:23], v74 offset:8192
    ds_read_b64_tr_b16 v[24:25], v6 offset:14336
    ds_read_b64_tr_b16 v[26:27], v6 offset:14848
    ds_read_b128 v[28:31], v75 offset:8192
    v_mfma_f32_32x32x16_bf16 v[32:47], v[104:107], v[108:111], v[32:47]
    s_waitcnt lgkmcnt(9)
    v_mfma_f32_32x32x16_bf16 v[32:47], v[112:115], v[116:119], v[32:47]
    v_mfma_f32_32x32x16_bf16 v[48:63], v[112:115], v[64:67], v[48:63]
    s_waitcnt lgkmcnt(6)
    v_mfma_f32_32x32x16_bf16 v[32:47], v[120:123], v[124:127], v[32:47]
    s_waitcnt lgkmcnt(3)
    v_mfma_f32_32x32x16_bf16 v[32:47], v[16:19], v[20:23], v[32:47]
    v_mfma_f32_32x32x16_bf16 v[48:63], v[16:19], v[64:67], v[48:63]
    s_waitcnt lgkmcnt(0)
    s_barrier
    ds_read_b64_tr_b16 v[80:81], v6 offset:16384
    ds_read_b64_tr_b16 v[82:83], v6 offset:16896
    ds_read_b128 v[84:87], v72 offset:16384
    ds_read_b64_tr_b16 v[88:89], v6 offset:18432
    ds_read_b64_tr_b16 v[90:91], v6 offset:18944
    ds_read_b128 v[92:95], v73 offset:16384
    ds_read_b64_tr_b16 v[96:97], v6 offset:20480
    ds_read_b64_tr_b16 v[98:99], v6 offset:20992
    ds_read_b128 v[100:103], v74 offset:16384
    ds_read_b64_tr_b16 v[104:105], v6 offset:22528
    ds_read_b64_tr_b16 v[106:107], v6 offset:23040
    ds_read_b128 v[108:111], v75 offset:16384
    v_mfma_f32_32x32x16_bf16 v[32:47], v[24:27], v[28:31], v[32:47]
    s_waitcnt lgkmcnt(9)
    v_mfma_f32_32x32x16_bf16 v[32:47], v[80:83], v[84:87], v[32:47]
    v_mfma_f32_32x32x16_bf16 v[48:63], v[80:83], v[64:67], v[48:63]
    s_waitcnt lgkmcnt(6)
    v_mfma_f32_32x32x16_bf16 v[32:47], v[88:91], v[92:95], v[32:47]
    s_waitcnt lgkmcnt(3)
    v_mfma_f32_32x32x16_bf16 v[32:47], v[96:99], v[100:103], v[32:47]
    v_mfma_f32_32x32x16_bf16 v[48:63], v[96:99], v[64:67], v[48:63]
    s_waitcnt lgkmcnt(0)
    ds_read_b64_tr_b16 v[112:113], v6 offset:24576
    ds_read_b64_tr_b16 v[114:115], v6 offset:25088
    ds_read_b128 v[116:119], v72 offset:24576
    ds_read_b64_tr_b16 v[120:121], v6 offset:26624
    ds_read_b64_tr_b16 v[122:123], v6 offset:27136
    ds_read_b128 v[124:127], v73 offset:24576
    ds_read_b64_tr_b16 v[16:17], v6 offset:28672
    ds_read_b64_tr_b16 v[18:19], v6 offset:29184
    ds_read_b128 v[20:23], v74 offset:24576
    ds_read_b64_tr_b16 v[24:25], v6 offset:30720
    ds_read_b64_tr_b16 v[26:27], v6 offset:31232
    ds_read_b128 v[28:31], v75 offset:24576
    v_mfma_f32_32x32x16_bf16 v[32:47], v[104:107], v[108:111], v[32:47]
    s_waitcnt lgkmcnt(9)
    v_mfma_f32_32x32x16_bf16 v[32:47], v[112:115], v[116:119], v[32:47]
    v_mfma_f32_32x32x16_bf16 v[48:63], v[112:115], v[64:67], v[48:63]
    s_waitcnt lgkmcnt(6)
    v_mfma_f32_32x32x16_bf16 v[32:47], v[120:123], v[124:127], v[32:47]
    s_waitcnt lgkmcnt(3)
    v_mfma_f32_32x32x16_bf16 v[32:47], v[16:19], v[20:23], v[32:47]
    v_mfma_f32_32x32x16_bf16 v[48:63], v[16:19], v[64:67], v[48:63]
    s_waitcnt lgkmcnt(0)
    s_barrier
    ds_read_b64_tr_b16 v[80:81], v6 offset:32768
    ds_read_b64_tr_b16 v[82:83], v6 offset:33280
    ds_read_b128 v[84:87], v72 offset:32768
    ds_read_b64_tr_b16 v[88:89], v6 offset:34816
    ds_read_b64_tr_b16 v[90:91], v6 offset:35328
    ds_read_b128 v[92:95], v73 offset:32768
    ds_read_b64_tr_b16 v[96:97], v6 offset:36864
    ds_read_b64_tr_b16 v[98:99], v6 offset:37376
    ds_read_b128 v[100:103], v74 offset:32768
    ds_read_b64_tr_b16 v[104:105], v6 offset:38912
    ds_read_b64_tr_b16 v[106:107], v6 offset:39424
    ds_read_b128 v[108:111], v75 offset:32768
    v_mfma_f32_32x32x16_bf16 v[32:47], v[24:27], v[28:31], v[32:47]
    s_waitcnt lgkmcnt(9)
    v_mfma_f32_32x32x16_bf16 v[32:47], v[80:83], v[84:87], v[32:47]
    v_mfma_f32_32x32x16_bf16 v[48:63], v[80:83], v[64:67], v[48:63]
    s_waitcnt lgkmcnt(6)
    v_mfma_f32_32x32x16_bf16 v[32:47], v[88:91], v[92:95], v[32:47]
    s_waitcnt lgkmcnt(3)
    v_mfma_f32_32x32x16_bf16 v[32:47], v[96:99], v[100:103], v[32:47]
    v_mfma_f32_32x32x16_bf16 v[48:63], v[96:99], v[64:67], v[48:63]
    s_waitcnt lgkmcnt(0)
    ds_read_b64_tr_b16 v[112:113], v6 offset:40960
    ds_read_b64_tr_b16 v[114:115], v6 offset:41472
    ds_read_b128 v[116:119], v72 offset:40960
    ds_read_b64_tr_b16 v[120:121], v6 offset:43008
    ds_read_b64_tr_b16 v[122:123], v6 offset:43520
    ds_read_b128 v[124:127], v73 offset:40960
    ds_read_b64_tr_b16 v[16:17], v6 offset:45056
    ds_read_b64_tr_b16 v[18:19], v6 offset:45568
    ds_read_b128 v[20:23], v74 offset:40960
    ds_read_b64_tr_b16 v[24:25], v6 offset:47104
    ds_read_b64_tr_b16 v[26:27], v6 offset:47616
    ds_read_b128 v[28:31], v75 offset:40960
    v_mfma_f32_32x32x16_bf16 v[32:47], v[104:107], v[108:111], v[32:47]
    s_waitcnt lgkmcnt(9)
    v_mfma_f32_32x32x16_bf16 v[32:47], v[112:115], v[116:119], v[32:47]
    v_mfma_f32_32x32x16_bf16 v[48:63], v[112:115], v[64:67], v[48:63]
    s_waitcnt lgkmcnt(6)
    v_mfma_f32_32x32x16_bf16 v[32:47], v[120:123], v[124:127], v[32:47]
    s_waitcnt lgkmcnt(3)
    v_mfma_f32_32x32x16_bf16 v[32:47], v[16:19], v[20:23], v[32:47]
    v_mfma_f32_32x32x16_bf16 v[48:63], v[16:19], v[64:67], v[48:63]
    s_waitcnt lgkmcnt(0)
    s_barrier
    ds_read_b64_tr_b16 v[80:81], v6 offset:49152
    ds_read_b64_tr_b16 v[82:83], v6 offset:49664
    ds_read_b128 v[84:87], v72 offset:49152
    ds_read_b64_tr_b16 v[88:89], v6 offset:51200
    ds_read_b64_tr_b16 v[90:91], v6 offset:51712
    ds_read_b128 v[92:95], v73 offset:49152
    ds_read_b64_tr_b16 v[96:97], v6 offset:53248
    ds_read_b64_tr_b16 v[98:99], v6 offset:53760
    ds_read_b128 v[100:103], v74 offset:49152
    ds_read_b64_tr_b16 v[104:105], v6 offset:55296
    ds_read_b64_tr_b16 v[106:107], v6 offset:55808
    ds_read_b128 v[108:111], v75 offset:49152
    v_mfma_f32_32x32x16_bf16 v[32:47], v[24:27], v[28:31], v[32:47]
    s_waitcnt lgkmcnt(9)
    v_mfma_f32_32x32x16_bf16 v[32:47], v[80:83], v[84:87], v[32:47]
    v_mfma_f32_32x32x16_bf16 v[48:63], v[80:83], v[64:67], v[48:63]
    s_waitcnt lgkmcnt(6)
    v_mfma_f32_32x32x16_bf16 v[32:47], v[88:91], v[92:95], v[32:47]
    s_waitcnt lgkmcnt(3)
    v_mfma_f32_32x32x16_bf16 v[32:47], v[96:99], v[100:103], v[32:47]
    v_mfma_f32_32x32x16_bf16 v[48:63], v[96:99], v[64:67], v[48:63]
    s_waitcnt lgkmcnt(0)
    ds_read_b64_tr_b16 v[112:113], v6 offset:57344
    ds_read_b64_tr_b16 v[114:115], v6 offset:57856
    ds_read_b128 v[116:119], v72 offset:57344
    ds_read_b64_tr_b16 v[120:121], v6 offset:59392
    ds_read_b64_tr_b16 v[122:123], v6 offset:59904
    ds_read_b128 v[124:127], v73 offset:57344
    ds_read_b64_tr_b16 v[16:17], v6 offset:61440
    ds_read_b64_tr_b16 v[18:19], v6 offset:61952
    ds_read_b128 v[20:23], v74 offset:57344
    ds_read_b64_tr_b16 v[24:25], v6 offset:63488
    ds_read_b64_tr_b16 v[26:27], v6 offset:64000
    ds_read_b128 v[28:31], v75 offset:57344
    v_mfma_f32_32x32x16_bf16 v[32:47], v[104:107], v[108:111], v[32:47]
    s_waitcnt lgkmcnt(9)
    v_mfma_f32_32x32x16_bf16 v[32:47], v[112:115], v[116:119], v[32:47]
    v_mfma_f32_32x32x16_bf16 v[48:63], v[112:115], v[64:67], v[48:63]
    s_waitcnt lgkmcnt(6)
    v_mfma_f32_32x32x16_bf16 v[32:47], v[120:123], v[124:127], v[32:47]
    s_waitcnt lgkmcnt(3)
    v_mfma_f32_32x32x16_bf16 v[32:47], v[16:19], v[20:23], v[32:47]
    v_mfma_f32_32x32x16_bf16 v[48:63], v[16:19], v[64:67], v[48:63]
    s_waitcnt lgkmcnt(0)
    v_mfma_f32_32x32x16_bf16 v[32:47], v[24:27], v[28:31], v[32:47]
    s_branch L_p0_qfin
L_p0_qcs:
    s_barrier
    ds_read_b64_tr_b16 v[80:81], v6 offset:0
    ds_read_b64_tr_b16 v[82:83], v6 offset:512
    ds_read_b128 v[84:87], v72 offset:0
    ds_read_b64_tr_b16 v[88:89], v6 offset:2048
    ds_read_b64_tr_b16 v[90:91], v6 offset:2560
    ds_read_b128 v[92:95], v73 offset:0
    ds_read_b64_tr_b16 v[96:97], v6 offset:4096
    ds_read_b64_tr_b16 v[98:99], v6 offset:4608
    ds_read_b128 v[100:103], v74 offset:0
    ds_read_b64_tr_b16 v[104:105], v6 offset:6144
    ds_read_b64_tr_b16 v[106:107], v6 offset:6656
    ds_read_b128 v[108:111], v75 offset:0
    s_waitcnt lgkmcnt(9)
    v_mfma_f32_32x32x16_bf16 v[32:47], v[80:83], v[84:87], v[32:47]
    s_waitcnt lgkmcnt(6)
    v_mfma_f32_32x32x16_bf16 v[32:47], v[88:91], v[92:95], v[32:47]
    v_mfma_f32_32x32x16_bf16 v[48:63], v[88:91], v[64:67], v[48:63]
    s_waitcnt lgkmcnt(3)
    v_mfma_f32_32x32x16_bf16 v[32:47], v[96:99], v[100:103], v[32:47]
    s_waitcnt lgkmcnt(0)
    ds_read_b64_tr_b16 v[112:113], v6 offset:8192
    ds_read_b64_tr_b16 v[114:115], v6 offset:8704
    ds_read_b128 v[116:119], v72 offset:8192
    ds_read_b64_tr_b16 v[120:121], v6 offset:10240
    ds_read_b64_tr_b16 v[122:123], v6 offset:10752
    ds_read_b128 v[124:127], v73 offset:8192
    ds_read_b64_tr_b16 v[16:17], v6 offset:12288
    ds_read_b64_tr_b16 v[18:19], v6 offset:12800
    ds_read_b128 v[20:23], v74 offset:8192
    ds_read_b64_tr_b16 v[24:25], v6 offset:14336
    ds_read_b64_tr_b16 v[26:27], v6 offset:14848
    ds_read_b128 v[28:31], v75 offset:8192
    v_mfma_f32_32x32x16_bf16 v[32:47], v[104:107], v[108:111], v[32:47]
    v_mfma_f32_32x32x16_bf16 v[48:63], v[104:107], v[64:67], v[48:63]
    s_waitcnt lgkmcnt(9)
    v_mfma_f32_32x32x16_bf16 v[32:47], v[112:115], v[116:119], v[32:47]
    s_waitcnt lgkmcnt(6)
    v_mfma_f32_32x32x16_bf16 v[32:47], v[120:123], v[124:127], v[32:47]
    v_mfma_f32_32x32x16_bf16 v[48:63], v[120:123], v[64:67], v[48:63]
    s_waitcnt lgkmcnt(3)
    v_mfma_f32_32x32x16_bf16 v[32:47], v[16:19], v[20:23], v[32:47]
    s_waitcnt lgkmcnt(0)
    s_barrier
    ds_read_b64_tr_b16 v[80:81], v6 offset:16384
    ds_read_b64_tr_b16 v[82:83], v6 offset:16896
    ds_read_b128 v[84:87], v72 offset:16384
    ds_read_b64_tr_b16 v[88:89], v6 offset:18432
    ds_read_b64_tr_b16 v[90:91], v6 offset:18944
    ds_read_b128 v[92:95], v73 offset:16384
    ds_read_b64_tr_b16 v[96:97], v6 offset:20480
    ds_read_b64_tr_b16 v[98:99], v6 offset:20992
    ds_read_b128 v[100:103], v74 offset:16384
    ds_read_b64_tr_b16 v[104:105], v6 offset:22528
    ds_read_b64_tr_b16 v[106:107], v6 offset:23040
    ds_read_b128 v[108:111], v75 offset:16384
    v_mfma_f32_32x32x16_bf16 v[32:47], v[24:27], v[28:31], v[32:47]
    v_mfma_f32_32x32x16_bf16 v[48:63], v[24:27], v[64:67], v[48:63]
    s_waitcnt lgkmcnt(9)
    v_mfma_f32_32x32x16_bf16 v[32:47], v[80:83], v[84:87], v[32:47]
    s_waitcnt lgkmcnt(6)
    v_mfma_f32_32x32x16_bf16 v[32:47], v[88:91], v[92:95], v[32:47]
    v_mfma_f32_32x32x16_bf16 v[48:63], v[88:91], v[64:67], v[48:63]
    s_waitcnt lgkmcnt(3)
    v_mfma_f32_32x32x16_bf16 v[32:47], v[96:99], v[100:103], v[32:47]
    s_waitcnt lgkmcnt(0)
    ds_read_b64_tr_b16 v[112:113], v6 offset:24576
    ds_read_b64_tr_b16 v[114:115], v6 offset:25088
    ds_read_b128 v[116:119], v72 offset:24576
    ds_read_b64_tr_b16 v[120:121], v6 offset:26624
    ds_read_b64_tr_b16 v[122:123], v6 offset:27136
    ds_read_b128 v[124:127], v73 offset:24576
    ds_read_b64_tr_b16 v[16:17], v6 offset:28672
    ds_read_b64_tr_b16 v[18:19], v6 offset:29184
    ds_read_b128 v[20:23], v74 offset:24576
    ds_read_b64_tr_b16 v[24:25], v6 offset:30720
    ds_read_b64_tr_b16 v[26:27], v6 offset:31232
    ds_read_b128 v[28:31], v75 offset:24576
    v_mfma_f32_32x32x16_bf16 v[32:47], v[104:107], v[108:111], v[32:47]
    v_mfma_f32_32x32x16_bf16 v[48:63], v[104:107], v[64:67], v[48:63]
    s_waitcnt lgkmcnt(9)
    v_mfma_f32_32x32x16_bf16 v[32:47], v[112:115], v[116:119], v[32:47]
    s_waitcnt lgkmcnt(6)
    v_mfma_f32_32x32x16_bf16 v[32:47], v[120:123], v[124:127], v[32:47]
    v_mfma_f32_32x32x16_bf16 v[48:63], v[120:123], v[64:67], v[48:63]
    s_waitcnt lgkmcnt(3)
    v_mfma_f32_32x32x16_bf16 v[32:47], v[16:19], v[20:23], v[32:47]
    s_waitcnt lgkmcnt(0)
    s_barrier
    ds_read_b64_tr_b16 v[80:81], v6 offset:32768
    ds_read_b64_tr_b16 v[82:83], v6 offset:33280
    ds_read_b128 v[84:87], v72 offset:32768
    ds_read_b64_tr_b16 v[88:89], v6 offset:34816
    ds_read_b64_tr_b16 v[90:91], v6 offset:35328
    ds_read_b128 v[92:95], v73 offset:32768
    ds_read_b64_tr_b16 v[96:97], v6 offset:36864
    ds_read_b64_tr_b16 v[98:99], v6 offset:37376
    ds_read_b128 v[100:103], v74 offset:32768
    ds_read_b64_tr_b16 v[104:105], v6 offset:38912
    ds_read_b64_tr_b16 v[106:107], v6 offset:39424
    ds_read_b128 v[108:111], v75 offset:32768
    v_mfma_f32_32x32x16_bf16 v[32:47], v[24:27], v[28:31], v[32:47]
    v_mfma_f32_32x32x16_bf16 v[48:63], v[24:27], v[64:67], v[48:63]
    s_waitcnt lgkmcnt(9)
    v_mfma_f32_32x32x16_bf16 v[32:47], v[80:83], v[84:87], v[32:47]
    s_waitcnt lgkmcnt(6)
    v_mfma_f32_32x32x16_bf16 v[32:47], v[88:91], v[92:95], v[32:47]
    v_mfma_f32_32x32x16_bf16 v[48:63], v[88:91], v[64:67], v[48:63]
    s_waitcnt lgkmcnt(3)
    v_mfma_f32_32x32x16_bf16 v[32:47], v[96:99], v[100:103], v[32:47]
    s_waitcnt lgkmcnt(0)
    ds_read_b64_tr_b16 v[112:113], v6 offset:40960
    ds_read_b64_tr_b16 v[114:115], v6 offset:41472
    ds_read_b128 v[116:119], v72 offset:40960
    ds_read_b64_tr_b16 v[120:121], v6 offset:43008
    ds_read_b64_tr_b16 v[122:123], v6 offset:43520
    ds_read_b128 v[124:127], v73 offset:40960
    ds_read_b64_tr_b16 v[16:17], v6 offset:45056
    ds_read_b64_tr_b16 v[18:19], v6 offset:45568
    ds_read_b128 v[20:23], v74 offset:40960
    ds_read_b64_tr_b16 v[24:25], v6 offset:47104
    ds_read_b64_tr_b16 v[26:27], v6 offset:47616
    ds_read_b128 v[28:31], v75 offset:40960
    v_mfma_f32_32x32x16_bf16 v[32:47], v[104:107], v[108:111], v[32:47]
    v_mfma_f32_32x32x16_bf16 v[48:63], v[104:107], v[64:67], v[48:63]
    s_waitcnt lgkmcnt(9)
    v_mfma_f32_32x32x16_bf16 v[32:47], v[112:115], v[116:119], v[32:47]
    s_waitcnt lgkmcnt(6)
    v_mfma_f32_32x32x16_bf16 v[32:47], v[120:123], v[124:127], v[32:47]
    v_mfma_f32_32x32x16_bf16 v[48:63], v[120:123], v[64:67], v[48:63]
    s_waitcnt lgkmcnt(3)
    v_mfma_f32_32x32x16_bf16 v[32:47], v[16:19], v[20:23], v[32:47]
    s_waitcnt lgkmcnt(0)
    s_barrier
    ds_read_b64_tr_b16 v[80:81], v6 offset:49152
    ds_read_b64_tr_b16 v[82:83], v6 offset:49664
    ds_read_b128 v[84:87], v72 offset:49152
    ds_read_b64_tr_b16 v[88:89], v6 offset:51200
    ds_read_b64_tr_b16 v[90:91], v6 offset:51712
    ds_read_b128 v[92:95], v73 offset:49152
    ds_read_b64_tr_b16 v[96:97], v6 offset:53248
    ds_read_b64_tr_b16 v[98:99], v6 offset:53760
    ds_read_b128 v[100:103], v74 offset:49152
    ds_read_b64_tr_b16 v[104:105], v6 offset:55296
    ds_read_b64_tr_b16 v[106:107], v6 offset:55808
    ds_read_b128 v[108:111], v75 offset:49152
    v_mfma_f32_32x32x16_bf16 v[32:47], v[24:27], v[28:31], v[32:47]
    v_mfma_f32_32x32x16_bf16 v[48:63], v[24:27], v[64:67], v[48:63]
    s_waitcnt lgkmcnt(9)
    v_mfma_f32_32x32x16_bf16 v[32:47], v[80:83], v[84:87], v[32:47]
    s_waitcnt lgkmcnt(6)
    v_mfma_f32_32x32x16_bf16 v[32:47], v[88:91], v[92:95], v[32:47]
    v_mfma_f32_32x32x16_bf16 v[48:63], v[88:91], v[64:67], v[48:63]
    s_waitcnt lgkmcnt(3)
    v_mfma_f32_32x32x16_bf16 v[32:47], v[96:99], v[100:103], v[32:47]
    s_waitcnt lgkmcnt(0)
    ds_read_b64_tr_b16 v[112:113], v6 offset:57344
    ds_read_b64_tr_b16 v[114:115], v6 offset:57856
    ds_read_b128 v[116:119], v72 offset:57344
    ds_read_b64_tr_b16 v[120:121], v6 offset:59392
    ds_read_b64_tr_b16 v[122:123], v6 offset:59904
    ds_read_b128 v[124:127], v73 offset:57344
    ds_read_b64_tr_b16 v[16:17], v6 offset:61440
    ds_read_b64_tr_b16 v[18:19], v6 offset:61952
    ds_read_b128 v[20:23], v74 offset:57344
    ds_read_b64_tr_b16 v[24:25], v6 offset:63488
    ds_read_b64_tr_b16 v[26:27], v6 offset:64000
    ds_read_b128 v[28:31], v75 offset:57344
    v_mfma_f32_32x32x16_bf16 v[32:47], v[104:107], v[108:111], v[32:47]
    v_mfma_f32_32x32x16_bf16 v[48:63], v[104:107], v[64:67], v[48:63]
    s_waitcnt lgkmcnt(9)
    v_mfma_f32_32x32x16_bf16 v[32:47], v[112:115], v[116:119], v[32:47]
    s_waitcnt lgkmcnt(6)
    v_mfma_f32_32x32x16_bf16 v[32:47], v[120:123], v[124:127], v[32:47]
    v_mfma_f32_32x32x16_bf16 v[48:63], v[120:123], v[64:67], v[48:63]
    s_waitcnt lgkmcnt(3)
    v_mfma_f32_32x32x16_bf16 v[32:47], v[16:19], v[20:23], v[32:47]
    s_waitcnt lgkmcnt(0)
    v_mfma_f32_32x32x16_bf16 v[32:47], v[24:27], v[28:31], v[32:47]
    v_mfma_f32_32x32x16_bf16 v[48:63], v[24:27], v[64:67], v[48:63]
L_p0_qfin:
    s_nop 7
    s_nop 3
    ds_write_b128 v77, v[48:51] offset:0
    ds_write_b128 v77, v[52:55] offset:32
    ds_write_b128 v77, v[56:59] offset:64
    ds_write_b128 v77, v[60:63] offset:96
    s_lshl_b32 s34, s33, 12
    s_lshl_b32 s35, s32, 10
    s_add_u32 s34, s34, s35
    s_add_u32 s34, s34, 131072
    v_add_u32 v70, s34, v2
    s_and_b32 s38, s28, 7
    s_lshr_b32 s39, s28, 3
    s_lshl_b32 s44, s39, 15
    s_lshl_b32 s47, s38, 10
    s_add_u32 s47, s47, s44
    v_add_u32 v3, s47, v2
    s_waitcnt lgkmcnt(0)
    s_barrier
    ds_read_b64 v[68:69], v76
    ds_read_b128 v[80:83], v78 offset:0
    ds_read_b128 v[84:87], v78 offset:32
    ds_read_b128 v[88:91], v78 offset:64
    ds_read_b128 v[92:95], v78 offset:96
    s_waitcnt lgkmcnt(0)
    v_mul_f32 v69, 0x3eb8aa3b, v69
    v_add_f32 v48, v48, v80
    v_add_f32 v49, v49, v81
    v_add_f32 v50, v50, v82
    v_add_f32 v51, v51, v83
    v_add_f32 v52, v52, v84
    v_add_f32 v53, v53, v85
    v_add_f32 v54, v54, v86
    v_add_f32 v55, v55, v87
    v_add_f32 v56, v56, v88
    v_add_f32 v57, v57, v89
    v_add_f32 v58, v58, v90
    v_add_f32 v59, v59, v91
    v_add_f32 v60, v60, v92
    v_add_f32 v61, v61, v93
    v_add_f32 v62, v62, v94
    v_add_f32 v63, v63, v95
    v_fma_f32 v32, -v68, v48, v32
    v_fma_f32 v33, -v68, v49, v33
    v_fma_f32 v34, -v68, v50, v34
    v_fma_f32 v35, -v68, v51, v35
    v_fma_f32 v36, -v68, v52, v36
    v_fma_f32 v37, -v68, v53, v37
    v_fma_f32 v38, -v68, v54, v38
    v_fma_f32 v39, -v68, v55, v39
    v_fma_f32 v40, -v68, v56, v40
    v_fma_f32 v41, -v68, v57, v41
    v_fma_f32 v42, -v68, v58, v42
    v_fma_f32 v43, -v68, v59, v43
    v_fma_f32 v44, -v68, v60, v44
    v_fma_f32 v45, -v68, v61, v45
    v_fma_f32 v46, -v68, v62, v46
    v_fma_f32 v47, -v68, v63, v47
    v_mul_f32 v32, v69, v32
    v_mul_f32 v33, v69, v33
    v_mul_f32 v34, v69, v34
    v_mul_f32 v35, v69, v35
    v_mul_f32 v36, v69, v36
    v_mul_f32 v37, v69, v37
    v_mul_f32 v38, v69, v38
    v_mul_f32 v39, v69, v39
    v_mul_f32 v40, v69, v40
    v_mul_f32 v41, v69, v41
    v_mul_f32 v42, v69, v42
    v_mul_f32 v43, v69, v43
    v_mul_f32 v44, v69, v44
    v_mul_f32 v45, v69, v45
    v_mul_f32 v46, v69, v46
    v_mul_f32 v47, v69, v47
    v_cvt_pk_bf16_f32 v48, v32, v33
    v_cvt_pk_bf16_f32 v49, v34, v35
    v_cvt_pk_bf16_f32 v50, v36, v37
    v_cvt_pk_bf16_f32 v51, v38, v39
    v_cvt_pk_bf16_f32 v52, v40, v41
    v_cvt_pk_bf16_f32 v53, v42, v43
    v_cvt_pk_bf16_f32 v54, v44, v45
    v_cvt_pk_bf16_f32 v55, v46, v47
    ds_write_b128 v70, v[48:51]
    ds_write_b128 v70, v[52:55] offset:2048
    s_lshl_b32 s33, s29, 1
    s_add_u32 s33, s33, s32
    s_lshl_b32 s33, s33, 5
    s_lshl_b32 s34, s30, 2
    s_add_u32 s33, s33, s34
    s_lshr_b32 s34, s38, 1
    s_add_u32 s33, s33, s34
    s_lshl_b32 s46, s33, 10
    s_lshl_b32 s34, s38, 10
    s_add_u32 s34, s34, 131072
    v_add_u32 v102, s34, v2
    v_mov_b32 v112, 0
    s_lshr_b32 s63, s29, 1
    s_lshl_b32 s63, s63, 11
    s_add_u32 s63, s63, 20447232
    v_add_u32 v100, s44, v2
    v_lshrrev_b32 v103, 5, v1
    v_and_b32 v106, 15, v1
    v_lshl_add_u32 v103, v103, 4, v106
    v_lshlrev_b32 v103, 4, v103
    v_add_u32 v103, s44, v103
    v_add_u32 v101, 65536, v103
    v_mov_b32 v103, 148224
    s_mov_b32 s40, 0x0000ffff
    s_mov_b32 s41, 0x0000ffff
    v_and_b32 v106, 31, v1
    v_cmp_eq_u32 vcc, 16, v106
    v_mov_b32 v107, 0x3f803f80
    s_nop 0
    v_cndmask_b32 v107, 0, v107, vcc
    s_mov_b32 s42, 1
    s_mov_b32 s36, 0
    s_movk_i32 s31, 82
    s_cmp_eq_u32 s28, 4
    s_cselect_b32 s31, 90, s31
    s_cmp_lg_u32 s62, 0
    s_cselect_b32 s31, 90, s31
    v_mov_b32 v118, 150080
    v_mov_b32 v119, 1
    v_mov_b32 v12, v107
    v_mov_b32 v13, v107
    v_mov_b32 v14, v107
    v_mov_b32 v15, v107
    v_mov_b32 v16, v107
    v_mov_b32 v17, v107
    v_mov_b32 v18, v107
    v_mov_b32 v19, v107
    v_mov_b32 v20, v107
    v_mov_b32 v21, v107
    v_mov_b32 v22, v107
    v_mov_b32 v23, v107
    v_mov_b32 v24, v107
    v_mov_b32 v25, v107
    v_mov_b32 v26, v107
    v_mov_b32 v27, v107
    v_mov_b32 v68, 0
    v_mov_b32 v69, 0
    v_mov_b32 v70, 0
    v_mov_b32 v71, 0
    v_mov_b32 v72, 0
    v_mov_b32 v73, 0
    v_mov_b32 v74, 0
    v_mov_b32 v75, 0
    v_mov_b32 v76, 0
    v_mov_b32 v77, 0
    v_mov_b32 v78, 0
    v_mov_b32 v79, 0
    v_mov_b32 v80, 0
    v_mov_b32 v81, 0
    v_mov_b32 v82, 0
    v_mov_b32 v83, 0
    v_mov_b32 v28, 0xdddddddd
    v_mov_b32 v60, 0
    v_mov_b32 v61, 0
    v_mov_b32 v62, 0
    v_mov_b32 v63, 0
    v_mov_b32 v64, 0
    v_mov_b32 v65, 0
    v_mov_b32 v66, 0
    v_mov_b32 v67, 0
    v_mov_b32 v107, 0x455ac000
    s_branch L_att2
L_p0_st:
    v_lshrrev_b32 v12, 2, v1
    s_lshl_b32 s34, s3, 4
    v_add_u32 v12, s34, v12
    v_lshlrev_b32 v7, 3, v12
    v_add_u32 v7, 147456, v7
    v_lshrrev_b32 v13, 1, v12
    v_and_b32 v13, 7, v13
    v_lshlrev_b32 v12, 7, v12
    v_lshlrev_b32 v14, 1, v11
    v_xor_b32 v14, v14, v13
    v_lshl_add_u32 v4, v14, 4, v12
    v_xor_b32 v5, 16, v4
    v_mov_b32 v64, 0x3f803f80
    v_mov_b32 v48, 0
    v_mov_b32 v49, 0
    v_mov_b32 v50, 0
    v_mov_b32 v51, 0
    s_waitcnt lgkmcnt(0)
    s_mov_b32 s24, s14
    s_mov_b32 s25, s15
    s_mov_b32 s26, 0x1700000
    s_mov_b32 s27, 0x00020000
    s_barrier
    ds_read_b128 v[16:19], v4 offset:0
    ds_read_b128 v[20:23], v5 offset:0
    ds_read_b128 v[24:27], v4 offset:8192
    ds_read_b128 v[28:31], v5 offset:8192
    s_waitcnt lgkmcnt(0)
    v_dot2_f32_bf16 v48, v16, v64, v48
    v_dot2_f32_bf16 v50, v16, v16, v50
    v_dot2_f32_bf16 v49, v17, v64, v49
    v_dot2_f32_bf16 v51, v17, v17, v51
    v_dot2_f32_bf16 v48, v18, v64, v48
    v_dot2_f32_bf16 v50, v18, v18, v50
    v_dot2_f32_bf16 v49, v19, v64, v49
    v_dot2_f32_bf16 v51, v19, v19, v51
    v_dot2_f32_bf16 v48, v20, v64, v48
    v_dot2_f32_bf16 v50, v20, v20, v50
    v_dot2_f32_bf16 v49, v21, v64, v49
    v_dot2_f32_bf16 v51, v21, v21, v51
    v_dot2_f32_bf16 v48, v22, v64, v48
    v_dot2_f32_bf16 v50, v22, v22, v50
    v_dot2_f32_bf16 v49, v23, v64, v49
    v_dot2_f32_bf16 v51, v23, v23, v51
    v_dot2_f32_bf16 v48, v24, v64, v48
    v_dot2_f32_bf16 v50, v24, v24, v50
    v_dot2_f32_bf16 v49, v25, v64, v49
    v_dot2_f32_bf16 v51, v25, v25, v51
    v_dot2_f32_bf16 v48, v26, v64, v48
    v_dot2_f32_bf16 v50, v26, v26, v50
    v_dot2_f32_bf16 v49, v27, v64, v49
    v_dot2_f32_bf16 v51, v27, v27, v51
    v_dot2_f32_bf16 v48, v28, v64, v48
    v_dot2_f32_bf16 v50, v28, v28, v50
    v_dot2_f32_bf16 v49, v29, v64, v49
    v_dot2_f32_bf16 v51, v29, v29, v51
    v_dot2_f32_bf16 v48, v30, v64, v48
    v_dot2_f32_bf16 v50, v30, v30, v50
    v_dot2_f32_bf16 v49, v31, v64, v49
    v_dot2_f32_bf16 v51, v31, v31, v51
    s_barrier
    ds_read_b128 v[16:19], v4 offset:16384
    ds_read_b128 v[20:23], v5 offset:16384
    ds_read_b128 v[24:27], v4 offset:24576
    ds_read_b128 v[28:31], v5 offset:24576
    s_waitcnt lgkmcnt(0)
    v_dot2_f32_bf16 v48, v16, v64, v48
    v_dot2_f32_bf16 v50, v16, v16, v50
    v_dot2_f32_bf16 v49, v17, v64, v49
    v_dot2_f32_bf16 v51, v17, v17, v51
    v_dot2_f32_bf16 v48, v18, v64, v48
    v_dot2_f32_bf16 v50, v18, v18, v50
    v_dot2_f32_bf16 v49, v19, v64, v49
    v_dot2_f32_bf16 v51, v19, v19, v51
    v_dot2_f32_bf16 v48, v20, v64, v48
    v_dot2_f32_bf16 v50, v20, v20, v50
    v_dot2_f32_bf16 v49, v21, v64, v49
    v_dot2_f32_bf16 v51, v21, v21, v51
    v_dot2_f32_bf16 v48, v22, v64, v48
    v_dot2_f32_bf16 v50, v22, v22, v50
    v_dot2_f32_bf16 v49, v23, v64, v49
    v_dot2_f32_bf16 v51, v23, v23, v51
    v_dot2_f32_bf16 v48, v24, v64, v48
    v_dot2_f32_bf16 v50, v24, v24, v50
    v_dot2_f32_bf16 v49, v25, v64, v49
    v_dot2_f32_bf16 v51, v25, v25, v51
    v_dot2_f32_bf16 v48, v26, v64, v48
    v_dot2_f32_bf16 v50, v26, v26, v50
    v_dot2_f32_bf16 v49, v27, v64, v49
    v_dot2_f32_bf16 v51, v27, v27, v51
    v_dot2_f32_bf16 v48, v28, v64, v48
    v_dot2_f32_bf16 v50, v28, v28, v50
    v_dot2_f32_bf16 v49, v29, v64, v49
    v_dot2_f32_bf16 v51, v29, v29, v51
    v_dot2_f32_bf16 v48, v30, v64, v48
    v_dot2_f32_bf16 v50, v30, v30, v50
    v_dot2_f32_bf16 v49, v31, v64, v49
    v_dot2_f32_bf16 v51, v31, v31, v51
    s_barrier
    ds_read_b128 v[16:19], v4 offset:32768
    ds_read_b128 v[20:23], v5 offset:32768
    ds_read_b128 v[24:27], v4 offset:40960
    ds_read_b128 v[28:31], v5 offset:40960
    s_waitcnt lgkmcnt(0)
    v_dot2_f32_bf16 v48, v16, v64, v48
    v_dot2_f32_bf16 v50, v16, v16, v50
    v_dot2_f32_bf16 v49, v17, v64, v49
    v_dot2_f32_bf16 v51, v17, v17, v51
    v_dot2_f32_bf16 v48, v18, v64, v48
    v_dot2_f32_bf16 v50, v18, v18, v50
    v_dot2_f32_bf16 v49, v19, v64, v49
    v_dot2_f32_bf16 v51, v19, v19, v51
    v_dot2_f32_bf16 v48, v20, v64, v48
    v_dot2_f32_bf16 v50, v20, v20, v50
    v_dot2_f32_bf16 v49, v21, v64, v49
    v_dot2_f32_bf16 v51, v21, v21, v51
    v_dot2_f32_bf16 v48, v22, v64, v48
    v_dot2_f32_bf16 v50, v22, v22, v50
    v_dot2_f32_bf16 v49, v23, v64, v49
    v_dot2_f32_bf16 v51, v23, v23, v51
    v_dot2_f32_bf16 v48, v24, v64, v48
    v_dot2_f32_bf16 v50, v24, v24, v50
    v_dot2_f32_bf16 v49, v25, v64, v49
    v_dot2_f32_bf16 v51, v25, v25, v51
    v_dot2_f32_bf16 v48, v26, v64, v48
    v_dot2_f32_bf16 v50, v26, v26, v50
    v_dot2_f32_bf16 v49, v27, v64, v49
    v_dot2_f32_bf16 v51, v27, v27, v51
    v_dot2_f32_bf16 v48, v28, v64, v48
    v_dot2_f32_bf16 v50, v28, v28, v50
    v_dot2_f32_bf16 v49, v29, v64, v49
    v_dot2_f32_bf16 v51, v29, v29, v51
    v_dot2_f32_bf16 v48, v30, v64, v48
    v_dot2_f32_bf16 v50, v30, v30, v50
    v_dot2_f32_bf16 v49, v31, v64, v49
    v_dot2_f32_bf16 v51, v31, v31, v51
    s_barrier
    ds_read_b128 v[16:19], v4 offset:49152
    ds_read_b128 v[20:23], v5 offset:49152
    ds_read_b128 v[24:27], v4 offset:57344
    ds_read_b128 v[28:31], v5 offset:57344
    s_waitcnt lgkmcnt(0)
    v_dot2_f32_bf16 v48, v16, v64, v48
    v_dot2_f32_bf16 v50, v16, v16, v50
    v_dot2_f32_bf16 v49, v17, v64, v49
    v_dot2_f32_bf16 v51, v17, v17, v51
    v_dot2_f32_bf16 v48, v18, v64, v48
    v_dot2_f32_bf16 v50, v18, v18, v50
    v_dot2_f32_bf16 v49, v19, v64, v49
    v_dot2_f32_bf16 v51, v19, v19, v51
    v_dot2_f32_bf16 v48, v20, v64, v48
    v_dot2_f32_bf16 v50, v20, v20, v50
    v_dot2_f32_bf16 v49, v21, v64, v49
    v_dot2_f32_bf16 v51, v21, v21, v51
    v_dot2_f32_bf16 v48, v22, v64, v48
    v_dot2_f32_bf16 v50, v22, v22, v50
    v_dot2_f32_bf16 v49, v23, v64, v49
    v_dot2_f32_bf16 v51, v23, v23, v51
    v_dot2_f32_bf16 v48, v24, v64, v48
    v_dot2_f32_bf16 v50, v24, v24, v50
    v_dot2_f32_bf16 v49, v25, v64, v49
    v_dot2_f32_bf16 v51, v25, v25, v51
    v_dot2_f32_bf16 v48, v26, v64, v48
    v_dot2_f32_bf16 v50, v26, v26, v50
    v_dot2_f32_bf16 v49, v27, v64, v49
    v_dot2_f32_bf16 v51, v27, v27, v51
    v_dot2_f32_bf16 v48, v28, v64, v48
    v_dot2_f32_bf16 v50, v28, v28, v50
    v_dot2_f32_bf16 v49, v29, v64, v49
    v_dot2_f32_bf16 v51, v29, v29, v51
    v_dot2_f32_bf16 v48, v30, v64, v48
    v_dot2_f32_bf16 v50, v30, v30, v50
    v_dot2_f32_bf16 v49, v31, v64, v49
    v_dot2_f32_bf16 v51, v31, v31, v51
    s_nop 1
    v_add_f32 v48, v48, v49
    v_add_f32 v49, v50, v51
    s_nop 0
    v_add_f32_dpp v48, v48, v48 quad_perm:[1,0,3,2] row_mask:0xf bank_mask:0xf
    v_add_f32_dpp v49, v49, v49 quad_perm:[1,0,3,2] row_mask:0xf bank_mask:0xf
    s_nop 0
    v_add_f32_dpp v48, v48, v48 quad_perm:[2,3,0,1] row_mask:0xf bank_mask:0xf
    v_add_f32_dpp v49, v49, v49 quad_perm:[2,3,0,1] row_mask:0xf bank_mask:0xf
    v_mul_f32 v48, 0x3b000000, v48
    v_mul_f32 v49, 0x3b000000, v49
    v_fma_f32 v12, -v48, v48, v49
    v_max_f32 v12, 0, v12
    v_add_f32 v12, 0x3727c5ac, v12
    v_rsq_f32 v49, v12
    ds_write_b64 v7, v[48:49]
    s_waitcnt lgkmcnt(0)
    s_barrier
    s_barrier
    s_barrier
    s_barrier
    s_barrier
    s_branch L_att
L_p0_n:
    v_mov_b32 v20, 0
    s_memrealtime s[58:59]
    s_waitcnt lgkmcnt(0)
    s_mov_b32 s24, s14
    s_mov_b32 s25, s15
    s_mov_b32 s26, 0x1700000
    s_mov_b32 s27, 0x00020000
    s_mov_b32 s16, s12
    s_mov_b32 s17, s13
    s_mov_b32 s18, 0x100
    s_mov_b32 s19, 0x00020000
    s_mov_b32 s20, s6
    s_mov_b32 s21, s7
    s_mov_b32 s22, 0x80000
    s_mov_b32 s23, 0x00020000
    s_lshr_b32 s34, s2, 3
    s_lshl_b32 s34, s34, 14
    s_add_u32 s35, s34, 8192
    v_lshlrev_b32 v24, 7, v1
    buffer_load_dword v25, v24, s[20:23], s34 offen
    buffer_load_dword v25, v24, s[20:23], s35 offen
    s_mov_b64 exec, 1
    s_cmp_eq_u32 s2, 0
    s_cbranch_scc0 L_p0_n1
    s_or_b32 s59, s59, 0x40000000
    v_mov_b32 v22, s58
    v_mov_b32 v23, s59
    buffer_store_dwordx2 v[22:23], v20, s[16:19], 0 offen sc1
L_p0_n1:
    s_barrier
    s_barrier
    s_mov_b32 s60, 0
L_p0_np:
    buffer_load_dwordx2 v[22:23], v20, s[16:19], 0 offen sc1
    s_add_u32 s60, s60, 1
    s_cmp_eq_u32 s60, 1
    s_cbranch_scc0 L_p0_nw
    s_barrier
    s_barrier
L_p0_nw:
    s_waitcnt vmcnt(0)
    v_cmp_eq_u32 vcc, 0, v23
    s_cmp_gt_u32 s60, 0x40000
    s_cbranch_scc1 L_p0_n2
    s_cbranch_vccnz L_p0_np
L_p0_n2:
    v_mov_b32 v21, 148224
    ds_write_b64 v21, v[22:23]
    v_readfirstlane_b32 s58, v22
    v_readfirstlane_b32 s59, v23
    s_mov_b64 exec, -1
    v_lshlrev_b32 v21, 2, v1
    v_add_u32 v21, 150016, v21
    v_cmp_eq_u32 vcc, 0, v1
    s_nop 1
    v_cndmask_b32 v22, 0, 2, vcc
    ds_write_b32 v21, v22
    v_mov_b32 v21, 148224
    v_lshlrev_b32 v26, 4, v1
    s_waitcnt lgkmcnt(0)
    s_barrier
    s_barrier
    s_barrier
    s_barrier
    s_barrier
    s_mov_b32 s60, 0
L_p0_gp:
    s_mov_b32 s34, 20709376
    buffer_load_dwordx3 v[28:30], v26, s[24:27], s34 offen sc1
    s_mov_b32 s34, 20710400
    buffer_load_dwordx3 v[32:34], v26, s[24:27], s34 offen sc1
    s_mov_b32 s34, 20711424
    buffer_load_dwordx3 v[36:38], v26, s[24:27], s34 offen sc1
    s_mov_b32 s34, 20712448
    buffer_load_dwordx3 v[40:42], v26, s[24:27], s34 offen sc1
    s_add_u32 s60, s60, 1
    s_waitcnt vmcnt(0)
    v_xor_b32 v28, s58, v28
    v_xor_b32 v29, s59, v29
    v_xor_b32 v32, s58, v32
    v_xor_b32 v33, s59, v33
    v_xor_b32 v36, s58, v36
    v_xor_b32 v37, s59, v37
    v_xor_b32 v40, s58, v40
    v_xor_b32 v41, s59, v41
    v_or3_b32 v28, v28, v29, v32
    v_or3_b32 v33, v33, v36, v37
    v_or3_b32 v28, v28, v40, v41
    v_or_b32 v28, v28, v33
    v_cmp_ne_u32 vcc, 0, v28
    s_cmp_gt_u32 s60, 0x40000
    s_cbranch_scc1 L_p0_g2
    s_cbranch_vccz L_p0_g2
    s_sleep 2
    s_branch L_p0_gp
L_p0_g2:
    v_max3_f32 v30, v30, v34, v38
    v_max_f32 v30, v30, v42
    s_nop 1
    v_max_f32_dpp v30, v30, v30 row_ror:1 row_mask:0xf bank_mask:0xf
    s_nop 1
    v_max_f32_dpp v30, v30, v30 row_ror:2 row_mask:0xf bank_mask:0xf
    s_nop 1
    v_max_f32_dpp v30, v30, v30 row_ror:4 row_mask:0xf bank_mask:0xf
    s_nop 1
    v_max_f32_dpp v30, v30, v30 row_ror:8 row_mask:0xf bank_mask:0xf
    v_mov_b32 v31, v30
    s_nop 1
    v_permlane16_swap_b32 v30, v31
    v_max_f32 v30, v30, v31
    v_mov_b32 v31, v30
    s_nop 1
    v_permlane32_swap_b32 v30, v31
    v_max_f32 v30, v30, v31
    ds_write_b32 v21, v30 offset:8
    s_and_b32 s34, s57, 3
    s_lshl_b32 s34, s34, 13
    s_add_u32 s34, s34, 15728640
    s_mov_b32 m0, 0
    s_add_u32 s35, s34, 0
    buffer_load_dwordx4 v2, s[24:27], s35 offen offset:0 sc1 lds
    buffer_load_dwordx4 v2, s[24:27], s35 offen offset:1024 sc1 lds
    buffer_load_dwordx4 v2, s[24:27], s35 offen offset:2048 sc1 lds
    buffer_load_dwordx4 v2, s[24:27], s35 offen offset:3072 sc1 lds
    s_mov_b32 m0, 4096
    s_add_u32 s35, s34, 4096
    buffer_load_dwordx4 v2, s[24:27], s35 offen offset:0 sc1 lds
    buffer_load_dwordx4 v2, s[24:27], s35 offen offset:1024 sc1 lds
    buffer_load_dwordx4 v2, s[24:27], s35 offen offset:2048 sc1 lds
    buffer_load_dwordx4 v2, s[24:27], s35 offen offset:3072 sc1 lds
    s_mov_b32 m0, 32768
    s_add_u32 s35, s34, 32768
    buffer_load_dwordx4 v2, s[24:27], s35 offen offset:0 sc1 lds
    buffer_load_dwordx4 v2, s[24:27], s35 offen offset:1024 sc1 lds
    buffer_load_dwordx4 v2, s[24:27], s35 offen offset:2048 sc1 lds
    buffer_load_dwordx4 v2, s[24:27], s35 offen offset:3072 sc1 lds
    s_mov_b32 m0, 36864
    s_add_u32 s35, s34, 36864
    buffer_load_dwordx4 v2, s[24:27], s35 offen offset:0 sc1 lds
    buffer_load_dwordx4 v2, s[24:27], s35 offen offset:1024 sc1 lds
    buffer_load_dwordx4 v2, s[24:27], s35 offen offset:2048 sc1 lds
    buffer_load_dwordx4 v2, s[24:27], s35 offen offset:3072 sc1 lds
    s_mov_b32 m0, 65536
    s_add_u32 s35, s34, 65536
    buffer_load_dwordx4 v2, s[24:27], s35 offen offset:0 sc1 lds
    buffer_load_dwordx4 v2, s[24:27], s35 offen offset:1024 sc1 lds
    buffer_load_dwordx4 v2, s[24:27], s35 offen offset:2048 sc1 lds
    buffer_load_dwordx4 v2, s[24:27], s35 offen offset:3072 sc1 lds
    s_mov_b32 m0, 69632
    s_add_u32 s35, s34, 69632
    buffer_load_dwordx4 v2, s[24:27], s35 offen offset:0 sc1 lds
    buffer_load_dwordx4 v2, s[24:27], s35 offen offset:1024 sc1 lds
    buffer_load_dwordx4 v2, s[24:27], s35 offen offset:2048 sc1 lds
    buffer_load_dwordx4 v2, s[24:27], s35 offen offset:3072 sc1 lds
    s_mov_b32 m0, 98304
    s_add_u32 s35, s34, 98304
    buffer_load_dwordx4 v2, s[24:27], s35 offen offset:0 sc1 lds
    buffer_load_dwordx4 v2, s[24:27], s35 offen offset:1024 sc1 lds
    buffer_load_dwordx4 v2, s[24:27], s35 offen offset:2048 sc1 lds
    buffer_load_dwordx4 v2, s[24:27], s35 offen offset:3072 sc1 lds
    s_mov_b32 m0, 102400
    s_add_u32 s35, s34, 102400
    buffer_load_dwordx4 v2, s[24:27], s35 offen offset:0 sc1 lds
    buffer_load_dwordx4 v2, s[24:27], s35 offen offset:1024 sc1 lds
    buffer_load_dwordx4 v2, s[24:27], s35 offen offset:2048 sc1 lds
    buffer_load_dwordx4 v2, s[24:27], s35 offen offset:3072 sc1 lds
    s_branch L_att
L_p0_kv:
    s_lshr_b32 s40, s30, 2
    s_and_b32 s41, s30, 3
    s_waitcnt lgkmcnt(0)
    s_cmp_eq_u32 s40, 0
    s_cselect_b32 s20, s8, s10
    s_cselect_b32 s21, s9, s11
    s_mov_b32 s22, 16384
    s_mov_b32 s23, 0x00020000
    s_mov_b32 s24, s14
    s_mov_b32 s25, s15
    s_mov_b32 s26, 0x1700000
    s_mov_b32 s27, 0x00020000
    s_mov_b32 m0, 131072
    s_lshl_b32 s38, s46, 11
    s_add_u32 s46, s46, 1
    buffer_load_dwordx4 v2, s[20:23], s38 offen lds
    buffer_load_dwordx4 v2, s[20:23], s38 offen offset:1024 lds
    s_and_b32 s46, s46, 7
    s_mov_b32 m0, 133120
    s_lshl_b32 s38, s46, 11
    s_add_u32 s46, s46, 1
    buffer_load_dwordx4 v2, s[20:23], s38 offen lds
    buffer_load_dwordx4 v2, s[20:23], s38 offen offset:1024 lds
    s_and_b32 s46, s46, 7
    s_mov_b32 m0, 135168
    s_lshl_b32 s38, s46, 11
    s_add_u32 s46, s46, 1
    buffer_load_dwordx4 v2, s[20:23], s38 offen lds
    buffer_load_dwordx4 v2, s[20:23], s38 offen offset:1024 lds
    s_and_b32 s46, s46, 7
    s_mov_b32 m0, 137216
    s_lshl_b32 s38, s46, 11
    s_add_u32 s46, s46, 1
    buffer_load_dwordx4 v2, s[20:23], s38 offen lds
    buffer_load_dwordx4 v2, s[20:23], s38 offen offset:1024 lds
    s_and_b32 s46, s46, 7
    s_mov_b32 m0, 139264
    s_lshl_b32 s38, s46, 11
    s_add_u32 s46, s46, 1
    buffer_load_dwordx4 v2, s[20:23], s38 offen lds
    buffer_load_dwordx4 v2, s[20:23], s38 offen offset:1024 lds
    s_and_b32 s46, s46, 7
    s_mov_b32 m0, 141312
    s_lshl_b32 s38, s46, 11
    s_add_u32 s46, s46, 1
    buffer_load_dwordx4 v2, s[20:23], s38 offen lds
    buffer_load_dwordx4 v2, s[20:23], s38 offen offset:1024 lds
    s_and_b32 s46, s46, 7
    s_mov_b32 m0, 143360
    s_lshl_b32 s38, s46, 11
    s_add_u32 s46, s46, 1
    buffer_load_dwordx4 v2, s[20:23], s38 offen lds
    buffer_load_dwordx4 v2, s[20:23], s38 offen offset:1024 lds
    s_and_b32 s46, s46, 7
    s_mov_b32 m0, 145408
    s_lshl_b32 s38, s46, 11
    s_add_u32 s46, s46, 1
    buffer_load_dwordx4 v2, s[20:23], s38 offen lds
    buffer_load_dwordx4 v2, s[20:23], s38 offen offset:1024 lds
    s_and_b32 s46, s46, 7
    v_mov_b32 v64, 0x3f803f80
    v_mov_b32 v65, 0x3f803f80
    v_mov_b32 v66, 0x3f803f80
    v_mov_b32 v67, 0x3f803f80
    v_and_b32 v15, 15, v1
    s_lshl_b32 s34, s41, 4
    v_add_u32 v12, s34, v15
    v_lshlrev_b32 v74, 3, v12
    v_add_u32 v74, 147456, v74
    v_lshl_add_u32 v75, v8, 2, s34
    v_lshlrev_b32 v75, 3, v75
    v_add_u32 v75, 147456, v75
    v_lshrrev_b32 v13, 1, v12
    v_and_b32 v13, 7, v13
    v_lshlrev_b32 v12, 7, v12
    v_xor_b32 v14, v8, v13
    v_lshl_add_u32 v72, v14, 4, v12
    v_add_u32 v14, 4, v8
    v_xor_b32 v14, v14, v13
    v_lshl_add_u32 v73, v14, 4, v12
    v_lshl_add_u32 v6, v8, 3, v10
    v_lshlrev_b32 v6, 5, v6
    v_lshl_add_u32 v6, v11, 3, v6
    v_add_u32 v6, 131072, v6
    s_lshl_b32 s34, s29, 2
    s_add_u32 s34, s34, s41
    v_and_b32 v12, 1, v8
    v_lshrrev_b32 v13, 1, v8
    v_mov_b32 v76, 148224
    s_and_b32 s37, s2, 7
    s_lshl_b32 s37, s37, 9
    s_lshr_b32 s36, s2, 3
    s_lshl_b32 s36, s36, 4
    s_add_u32 s37, s37, s36
    s_add_u32 s37, s37, 20709376
    v_mov_b32 v32, 0
    v_mov_b32 v33, 0
    v_mov_b32 v34, 0
    v_mov_b32 v35, 0
    v_mov_b32 v36, 0
    v_mov_b32 v37, 0
    v_mov_b32 v38, 0
    v_mov_b32 v39, 0
    s_cmp_eq_u32 s40, 0
    s_cbranch_scc0 L_p0_v
    s_waitcnt vmcnt(12)
    s_barrier
    ds_read_b64_tr_b16 v[80:81], v6 offset:0
    ds_read_b64_tr_b16 v[82:83], v6 offset:128
    ds_read_b128 v[84:87], v72 offset:0
    ds_read_b64_tr_b16 v[88:89], v6 offset:1024
    ds_read_b64_tr_b16 v[90:91], v6 offset:1152
    ds_read_b128 v[92:95], v73 offset:0
    ds_read_b64_tr_b16 v[96:97], v6 offset:2048
    ds_read_b64_tr_b16 v[98:99], v6 offset:2176
    ds_read_b128 v[100:103], v72 offset:8192
    ds_read_b64_tr_b16 v[104:105], v6 offset:3072
    ds_read_b64_tr_b16 v[106:107], v6 offset:3200
    ds_read_b128 v[108:111], v73 offset:8192
    s_waitcnt lgkmcnt(9)
    v_mfma_f32_16x16x32_bf16 v[32:35], v[80:83], v[84:87], v[32:35]
    v_mfma_f32_16x16x32_bf16 v[36:39], v[80:83], v[64:67], v[36:39]
    s_waitcnt lgkmcnt(6)
    v_mfma_f32_16x16x32_bf16 v[32:35], v[88:91], v[92:95], v[32:35]
    v_mfma_f32_16x16x32_bf16 v[36:39], v[88:91], v[64:67], v[36:39]
    s_waitcnt lgkmcnt(3)
    v_mfma_f32_16x16x32_bf16 v[32:35], v[96:99], v[100:103], v[32:35]
    v_mfma_f32_16x16x32_bf16 v[36:39], v[96:99], v[64:67], v[36:39]
    s_waitcnt lgkmcnt(0)
    v_mfma_f32_16x16x32_bf16 v[32:35], v[104:107], v[108:111], v[32:35]
    v_mfma_f32_16x16x32_bf16 v[36:39], v[104:107], v[64:67], v[36:39]
    s_waitcnt vmcnt(8)
    s_barrier
    ds_read_b64_tr_b16 v[80:81], v6 offset:4096
    ds_read_b64_tr_b16 v[82:83], v6 offset:4224
    ds_read_b128 v[84:87], v72 offset:16384
    ds_read_b64_tr_b16 v[88:89], v6 offset:5120
    ds_read_b64_tr_b16 v[90:91], v6 offset:5248
    ds_read_b128 v[92:95], v73 offset:16384
    ds_read_b64_tr_b16 v[96:97], v6 offset:6144
    ds_read_b64_tr_b16 v[98:99], v6 offset:6272
    ds_read_b128 v[100:103], v72 offset:24576
    ds_read_b64_tr_b16 v[104:105], v6 offset:7168
    ds_read_b64_tr_b16 v[106:107], v6 offset:7296
    ds_read_b128 v[108:111], v73 offset:24576
    s_waitcnt lgkmcnt(9)
    v_mfma_f32_16x16x32_bf16 v[32:35], v[80:83], v[84:87], v[32:35]
    v_mfma_f32_16x16x32_bf16 v[36:39], v[80:83], v[64:67], v[36:39]
    s_waitcnt lgkmcnt(6)
    v_mfma_f32_16x16x32_bf16 v[32:35], v[88:91], v[92:95], v[32:35]
    v_mfma_f32_16x16x32_bf16 v[36:39], v[88:91], v[64:67], v[36:39]
    s_waitcnt lgkmcnt(3)
    v_mfma_f32_16x16x32_bf16 v[32:35], v[96:99], v[100:103], v[32:35]
    v_mfma_f32_16x16x32_bf16 v[36:39], v[96:99], v[64:67], v[36:39]
    s_waitcnt lgkmcnt(0)
    v_mfma_f32_16x16x32_bf16 v[32:35], v[104:107], v[108:111], v[32:35]
    v_mfma_f32_16x16x32_bf16 v[36:39], v[104:107], v[64:67], v[36:39]
    s_waitcnt vmcnt(4)
    s_barrier
    ds_read_b64_tr_b16 v[80:81], v6 offset:8192
    ds_read_b64_tr_b16 v[82:83], v6 offset:8320
    ds_read_b128 v[84:87], v72 offset:32768
    ds_read_b64_tr_b16 v[88:89], v6 offset:9216
    ds_read_b64_tr_b16 v[90:91], v6 offset:9344
    ds_read_b128 v[92:95], v73 offset:32768
    ds_read_b64_tr_b16 v[96:97], v6 offset:10240
    ds_read_b64_tr_b16 v[98:99], v6 offset:10368
    ds_read_b128 v[100:103], v72 offset:40960
    ds_read_b64_tr_b16 v[104:105], v6 offset:11264
    ds_read_b64_tr_b16 v[106:107], v6 offset:11392
    ds_read_b128 v[108:111], v73 offset:40960
    s_waitcnt lgkmcnt(9)
    v_mfma_f32_16x16x32_bf16 v[32:35], v[80:83], v[84:87], v[32:35]
    v_mfma_f32_16x16x32_bf16 v[36:39], v[80:83], v[64:67], v[36:39]
    s_waitcnt lgkmcnt(6)
    v_mfma_f32_16x16x32_bf16 v[32:35], v[88:91], v[92:95], v[32:35]
    v_mfma_f32_16x16x32_bf16 v[36:39], v[88:91], v[64:67], v[36:39]
    s_waitcnt lgkmcnt(3)
    v_mfma_f32_16x16x32_bf16 v[32:35], v[96:99], v[100:103], v[32:35]
    v_mfma_f32_16x16x32_bf16 v[36:39], v[96:99], v[64:67], v[36:39]
    s_waitcnt lgkmcnt(0)
    v_mfma_f32_16x16x32_bf16 v[32:35], v[104:107], v[108:111], v[32:35]
    v_mfma_f32_16x16x32_bf16 v[36:39], v[104:107], v[64:67], v[36:39]
    s_waitcnt vmcnt(0)
    s_barrier
    ds_read_b64_tr_b16 v[80:81], v6 offset:12288
    ds_read_b64_tr_b16 v[82:83], v6 offset:12416
    ds_read_b128 v[84:87], v72 offset:49152
    ds_read_b64_tr_b16 v[88:89], v6 offset:13312
    ds_read_b64_tr_b16 v[90:91], v6 offset:13440
    ds_read_b128 v[92:95], v73 offset:49152
    ds_read_b64_tr_b16 v[96:97], v6 offset:14336
    ds_read_b64_tr_b16 v[98:99], v6 offset:14464
    ds_read_b128 v[100:103], v72 offset:57344
    ds_read_b64_tr_b16 v[104:105], v6 offset:15360
    ds_read_b64_tr_b16 v[106:107], v6 offset:15488
    ds_read_b128 v[108:111], v73 offset:57344
    s_waitcnt lgkmcnt(9)
    v_mfma_f32_16x16x32_bf16 v[32:35], v[80:83], v[84:87], v[32:35]
    v_mfma_f32_16x16x32_bf16 v[36:39], v[80:83], v[64:67], v[36:39]
    s_waitcnt lgkmcnt(6)
    v_mfma_f32_16x16x32_bf16 v[32:35], v[88:91], v[92:95], v[32:35]
    v_mfma_f32_16x16x32_bf16 v[36:39], v[88:91], v[64:67], v[36:39]
    s_waitcnt lgkmcnt(3)
    v_mfma_f32_16x16x32_bf16 v[32:35], v[96:99], v[100:103], v[32:35]
    v_mfma_f32_16x16x32_bf16 v[36:39], v[96:99], v[64:67], v[36:39]
    s_waitcnt lgkmcnt(0)
    v_mfma_f32_16x16x32_bf16 v[32:35], v[104:107], v[108:111], v[32:35]
    v_mfma_f32_16x16x32_bf16 v[36:39], v[104:107], v[64:67], v[36:39]
    s_barrier
    ds_read_b64 v[40:41], v76
    ds_read_b64 v[68:69], v74
    v_lshlrev_b32 v3, 9, v12
    v_lshl_add_u32 v3, v15, 4, v3
    v_lshl_add_u32 v3, v13, 3, v3
    s_lshr_b32 s35, s34, 1
    s_lshl_b32 s35, s35, 10
    s_and_b32 s36, s34, 1
    s_lshl_b32 s36, s36, 8
    s_add_u32 s35, s35, s36
    s_add_u32 s35, s35, 15728640
    s_waitcnt lgkmcnt(0)
    v_fma_f32 v32, -v68, v36, v32
    v_fma_f32 v33, -v68, v37, v33
    v_fma_f32 v34, -v68, v38, v34
    v_fma_f32 v35, -v68, v39, v35
    v_mul_f32 v32, v69, v32
    v_mul_f32 v33, v69, v33
    v_mul_f32 v34, v69, v34
    v_mul_f32 v35, v69, v35
    v_cvt_pk_bf16_f32 v36, v32, v33
    v_cvt_pk_bf16_f32 v37, v34, v35
    buffer_store_dwordx2 v[36:37], v3, s[24:27], s35 offen sc1
    v_dot2_f32_bf16 v42, v36, v36, 0
    v_dot2_f32_bf16 v42, v37, v37, v42
    s_nop 2
    v_mov_b32 v12, v42
    s_nop 1
    v_permlane32_swap_b32 v42, v12
    v_add_f32 v42, v42, v12
    v_mov_b32 v12, v42
    s_nop 1
    v_permlane16_swap_b32 v42, v12
    v_add_f32 v42, v42, v12
    s_nop 1
    v_max_f32_dpp v42, v42, v42 row_ror:1 row_mask:0xf bank_mask:0xf
    s_nop 1
    v_max_f32_dpp v42, v42, v42 row_ror:2 row_mask:0xf bank_mask:0xf
    s_nop 1
    v_max_f32_dpp v42, v42, v42 row_ror:4 row_mask:0xf bank_mask:0xf
    s_nop 1
    v_max_f32_dpp v42, v42, v42 row_ror:8 row_mask:0xf bank_mask:0xf
    s_branch L_p0_kvf
L_p0_v:
    s_waitcnt vmcnt(12)
    s_barrier
    ds_read_b64_tr_b16 v[80:81], v6 offset:0
    ds_read_b64_tr_b16 v[82:83], v6 offset:128
    ds_read_b128 v[84:87], v72 offset:0
    ds_read_b64_tr_b16 v[88:89], v6 offset:1024
    ds_read_b64_tr_b16 v[90:91], v6 offset:1152
    ds_read_b128 v[92:95], v73 offset:0
    ds_read_b64_tr_b16 v[96:97], v6 offset:2048
    ds_read_b64_tr_b16 v[98:99], v6 offset:2176
    ds_read_b128 v[100:103], v72 offset:8192
    ds_read_b64_tr_b16 v[104:105], v6 offset:3072
    ds_read_b64_tr_b16 v[106:107], v6 offset:3200
    ds_read_b128 v[108:111], v73 offset:8192
    s_waitcnt lgkmcnt(9)
    v_mfma_f32_16x16x32_bf16 v[32:35], v[84:87], v[80:83], v[32:35]
    v_mfma_f32_16x16x32_bf16 v[36:39], v[64:67], v[80:83], v[36:39]
    s_waitcnt lgkmcnt(6)
    v_mfma_f32_16x16x32_bf16 v[32:35], v[92:95], v[88:91], v[32:35]
    v_mfma_f32_16x16x32_bf16 v[36:39], v[64:67], v[88:91], v[36:39]
    s_waitcnt lgkmcnt(3)
    v_mfma_f32_16x16x32_bf16 v[32:35], v[100:103], v[96:99], v[32:35]
    v_mfma_f32_16x16x32_bf16 v[36:39], v[64:67], v[96:99], v[36:39]
    s_waitcnt lgkmcnt(0)
    v_mfma_f32_16x16x32_bf16 v[32:35], v[108:111], v[104:107], v[32:35]
    v_mfma_f32_16x16x32_bf16 v[36:39], v[64:67], v[104:107], v[36:39]
    s_waitcnt vmcnt(8)
    s_barrier
    ds_read_b64_tr_b16 v[80:81], v6 offset:4096
    ds_read_b64_tr_b16 v[82:83], v6 offset:4224
    ds_read_b128 v[84:87], v72 offset:16384
    ds_read_b64_tr_b16 v[88:89], v6 offset:5120
    ds_read_b64_tr_b16 v[90:91], v6 offset:5248
    ds_read_b128 v[92:95], v73 offset:16384
    ds_read_b64_tr_b16 v[96:97], v6 offset:6144
    ds_read_b64_tr_b16 v[98:99], v6 offset:6272
    ds_read_b128 v[100:103], v72 offset:24576
    ds_read_b64_tr_b16 v[104:105], v6 offset:7168
    ds_read_b64_tr_b16 v[106:107], v6 offset:7296
    ds_read_b128 v[108:111], v73 offset:24576
    s_waitcnt lgkmcnt(9)
    v_mfma_f32_16x16x32_bf16 v[32:35], v[84:87], v[80:83], v[32:35]
    v_mfma_f32_16x16x32_bf16 v[36:39], v[64:67], v[80:83], v[36:39]
    s_waitcnt lgkmcnt(6)
    v_mfma_f32_16x16x32_bf16 v[32:35], v[92:95], v[88:91], v[32:35]
    v_mfma_f32_16x16x32_bf16 v[36:39], v[64:67], v[88:91], v[36:39]
    s_waitcnt lgkmcnt(3)
    v_mfma_f32_16x16x32_bf16 v[32:35], v[100:103], v[96:99], v[32:35]
    v_mfma_f32_16x16x32_bf16 v[36:39], v[64:67], v[96:99], v[36:39]
    s_waitcnt lgkmcnt(0)
    v_mfma_f32_16x16x32_bf16 v[32:35], v[108:111], v[104:107], v[32:35]
    v_mfma_f32_16x16x32_bf16 v[36:39], v[64:67], v[104:107], v[36:39]
    s_waitcnt vmcnt(4)
    s_barrier
    ds_read_b64_tr_b16 v[80:81], v6 offset:8192
    ds_read_b64_tr_b16 v[82:83], v6 offset:8320
    ds_read_b128 v[84:87], v72 offset:32768
    ds_read_b64_tr_b16 v[88:89], v6 offset:9216
    ds_read_b64_tr_b16 v[90:91], v6 offset:9344
    ds_read_b128 v[92:95], v73 offset:32768
    ds_read_b64_tr_b16 v[96:97], v6 offset:10240
    ds_read_b64_tr_b16 v[98:99], v6 offset:10368
    ds_read_b128 v[100:103], v72 offset:40960
    ds_read_b64_tr_b16 v[104:105], v6 offset:11264
    ds_read_b64_tr_b16 v[106:107], v6 offset:11392
    ds_read_b128 v[108:111], v73 offset:40960
    s_waitcnt lgkmcnt(9)
    v_mfma_f32_16x16x32_bf16 v[32:35], v[84:87], v[80:83], v[32:35]
    v_mfma_f32_16x16x32_bf16 v[36:39], v[64:67], v[80:83], v[36:39]
    s_waitcnt lgkmcnt(6)
    v_mfma_f32_16x16x32_bf16 v[32:35], v[92:95], v[88:91], v[32:35]
    v_mfma_f32_16x16x32_bf16 v[36:39], v[64:67], v[88:91], v[36:39]
    s_waitcnt lgkmcnt(3)
    v_mfma_f32_16x16x32_bf16 v[32:35], v[100:103], v[96:99], v[32:35]
    v_mfma_f32_16x16x32_bf16 v[36:39], v[64:67], v[96:99], v[36:39]
    s_waitcnt lgkmcnt(0)
    v_mfma_f32_16x16x32_bf16 v[32:35], v[108:111], v[104:107], v[32:35]
    v_mfma_f32_16x16x32_bf16 v[36:39], v[64:67], v[104:107], v[36:39]
    s_waitcnt vmcnt(0)
    s_barrier
    ds_read_b64_tr_b16 v[80:81], v6 offset:12288
    ds_read_b64_tr_b16 v[82:83], v6 offset:12416
    ds_read_b128 v[84:87], v72 offset:49152
    ds_read_b64_tr_b16 v[88:89], v6 offset:13312
    ds_read_b64_tr_b16 v[90:91], v6 offset:13440
    ds_read_b128 v[92:95], v73 offset:49152
    ds_read_b64_tr_b16 v[96:97], v6 offset:14336
    ds_read_b64_tr_b16 v[98:99], v6 offset:14464
    ds_read_b128 v[100:103], v72 offset:57344
    ds_read_b64_tr_b16 v[104:105], v6 offset:15360
    ds_read_b64_tr_b16 v[106:107], v6 offset:15488
    ds_read_b128 v[108:111], v73 offset:57344
    s_waitcnt lgkmcnt(9)
    v_mfma_f32_16x16x32_bf16 v[32:35], v[84:87], v[80:83], v[32:35]
    v_mfma_f32_16x16x32_bf16 v[36:39], v[64:67], v[80:83], v[36:39]
    s_waitcnt lgkmcnt(6)
    v_mfma_f32_16x16x32_bf16 v[32:35], v[92:95], v[88:91], v[32:35]
    v_mfma_f32_16x16x32_bf16 v[36:39], v[64:67], v[88:91], v[36:39]
    s_waitcnt lgkmcnt(3)
    v_mfma_f32_16x16x32_bf16 v[32:35], v[100:103], v[96:99], v[32:35]
    v_mfma_f32_16x16x32_bf16 v[36:39], v[64:67], v[96:99], v[36:39]
    s_waitcnt lgkmcnt(0)
    v_mfma_f32_16x16x32_bf16 v[32:35], v[108:111], v[104:107], v[32:35]
    v_mfma_f32_16x16x32_bf16 v[36:39], v[64:67], v[104:107], v[36:39]
    s_barrier
    ds_read_b64 v[40:41], v76
    ds_read_b128 v[56:59], v75
    ds_read_b128 v[60:63], v75 offset:16
    v_lshlrev_b32 v3, 8, v13
    v_lshl_add_u32 v3, v15, 4, v3
    v_lshl_add_u32 v3, v12, 3, v3
    s_lshl_b32 s35, s34, 9
    s_add_u32 s35, s35, 15794176
    v_mov_b32 v42, 0
    s_waitcnt lgkmcnt(0)
    v_fma_f32 v32, -v56, v36, v32
    v_fma_f32 v33, -v58, v37, v33
    v_fma_f32 v34, -v60, v38, v34
    v_fma_f32 v35, -v62, v39, v35
    v_mul_f32 v32, v57, v32
    v_mul_f32 v33, v59, v33
    v_mul_f32 v34, v61, v34
    v_mul_f32 v35, v63, v35
    v_cvt_pk_bf16_f32 v36, v32, v33
    v_cvt_pk_bf16_f32 v37, v34, v35
    buffer_store_dwordx2 v[36:37], v3, s[24:27], s35 offen sc1
L_p0_kvf:
    v_mov_b32 v43, 0
    s_barrier
    s_waitcnt vmcnt(0)
    s_mov_b64 exec, 1
    buffer_store_dwordx4 v[40:43], v43, s[24:27], s37 offen sc1
    s_mov_b64 exec, -1
    s_barrier
    s_barrier
    s_barrier
    s_branch L_att
L_p0_pack:
    s_load_dwordx2 s[48:49], s[0:1], 48
    s_load_dwordx2 s[50:51], s[0:1], 32
    s_load_dwordx2 s[52:53], s[0:1], 72
    s_lshl_b32 s35, s28, 8
    s_add_u32 s35, s35, s2
    s_lshl_b32 s36, s28, 13
    s_add_u32 s36, s36, 131072
    s_waitcnt lgkmcnt(0)
    s_mov_b32 s24, s14
    s_mov_b32 s25, s15
    s_mov_b32 s26, 0x1700000
    s_mov_b32 s27, 0x00020000
    s_cmp_lt_u32 s35, 332
    s_cbranch_scc1 L_pk_job
L_pk_done:
    s_barrier
    s_barrier
    s_barrier
    s_barrier
    s_barrier
    s_barrier
    s_barrier
    s_barrier
    s_barrier
    s_branch L_att
L_pk_job:
    s_lshl_b32 s62, s35, 7
    s_add_u32 s62, s62, 20742144
    s_mov_b32 s23, 0x00020000
    s_cmp_lt_u32 s35, 172
    s_cbranch_scc1 L_pk_in
    s_movk_i32 s40, 1024
    s_cmp_lt_u32 s35, 236
    s_cbranch_scc1 L_pk_o
    s_sub_u32 s35, s35, 236
    s_mul_i32 s37, s35, 171
    s_lshr_b32 s37, s37, 9
    s_mul_i32 s38, s37, 3
    s_sub_u32 s38, s35, s38
    s_mov_b32 s20, s52
    s_mov_b32 s21, s53
    s_mov_b32 s22, 704512
    s_mul_i32 s39, s37, 24576
    s_add_u32 s39, s39, 23068672
    s_branch L_pk_d
L_pk_o:
    s_sub_u32 s35, s35, 172
    s_lshr_b32 s37, s35, 1
    s_and_b32 s38, s35, 1
    s_mov_b32 s20, s50
    s_mov_b32 s21, s51
    s_mov_b32 s22, 524288
    s_lshl_b32 s39, s37, 14
    s_add_u32 s39, s39, 22544384
L_pk_d:
    v_lshrrev_b32 v12, 1, v8
    v_lshlrev_b32 v6, 4, v12
    v_and_b32 v12, 1, v8
    v_lshl_add_u32 v6, v12, 2, v6
    s_movk_i32 s41, 256
    s_mov_b32 s42, 0
    s_branch L_pk_go
L_pk_in:
    s_movk_i32 s40, 2752
    s_lshr_b32 s37, s35, 1
    s_and_b32 s38, s35, 1
    s_mov_b32 s20, s48
    s_mov_b32 s21, s49
    s_mov_b32 s22, 1409024
    s_lshl_b32 s39, s37, 14
    s_add_u32 s39, s39, 20971520
    v_lshlrev_b32 v6, 2, v8
    s_movk_i32 s41, 512
    s_mov_b32 s42, 1
L_pk_go:
    v_add_u32 v6, v6, v10
    v_lshlrev_b32 v6, 5, v6
    v_lshl_add_u32 v6, v11, 3, v6
    v_add_u32 v108, s36, v6
    v_add_u32 v109, s41, v108
    s_lshl_b32 s43, s38, 13
    s_add_u32 s48, s39, s43
    v_lshrrev_b32 v113, 1, v1
    v_mul_lo_u32 v113, v113, s40
    v_and_b32 v12, 1, v1
    v_lshl_add_u32 v113, v12, 4, v113
    s_lshl_b32 s50, s40, 8
    s_mul_i32 s50, s50, s38
    s_lshl_b32 s44, s37, 5
    s_add_u32 s50, s50, s44
    s_lshl_b32 s51, s40, 5
    s_lshl_b32 s49, s37, 6
    s_add_u32 s49, s49, s43
    s_add_u32 s49, s49, 16187392
    s_mul_i32 s49, s49, s42
    s_mov_b32 s45, s36
    s_branch L_pk_done
L_att:
    s_and_b32 s38, s28, 7
    s_lshr_b32 s39, s28, 3
    s_lshl_b32 s44, s39, 15
    s_lshl_b32 s47, s38, 10
    s_add_u32 s47, s47, s44
    v_add_u32 v3, s47, v2
    s_lshl_b32 s33, s29, 1
    s_add_u32 s33, s33, s32
    s_lshl_b32 s33, s33, 5
    s_lshl_b32 s34, s30, 2
    s_add_u32 s33, s33, s34
    s_lshr_b32 s34, s38, 1
    s_add_u32 s33, s33, s34
    s_lshl_b32 s46, s33, 10
    s_lshl_b32 s34, s38, 10
    s_add_u32 s34, s34, 131072
    v_add_u32 v102, s34, v2
    v_mov_b32 v112, 0
    s_lshr_b32 s63, s29, 1
    s_lshl_b32 s63, s63, 11
    s_add_u32 s63, s63, 20447232
    v_add_u32 v100, s44, v2
    v_lshrrev_b32 v103, 5, v1
    v_and_b32 v106, 15, v1
    v_lshl_add_u32 v103, v103, 4, v106
    v_lshlrev_b32 v103, 4, v103
    v_add_u32 v103, s44, v103
    v_add_u32 v101, 65536, v103
    v_mov_b32 v103, 148224
    s_mov_b32 s40, 0x0000ffff
    s_mov_b32 s41, 0x0000ffff
    v_and_b32 v106, 31, v1
    v_cmp_eq_u32 vcc, 16, v106
    v_mov_b32 v107, 0x3f803f80
    s_nop 0
    v_cndmask_b32 v107, 0, v107, vcc
    s_mov_b32 s42, 1
    s_mov_b32 s36, 0
    s_movk_i32 s31, 82
    s_cmp_eq_u32 s28, 4
    s_cselect_b32 s31, 90, s31
    s_cmp_lg_u32 s62, 0
    s_cselect_b32 s31, 90, s31
    v_mov_b32 v118, 150080
    v_mov_b32 v119, 1
    v_mov_b32 v12, v107
    v_mov_b32 v13, v107
    v_mov_b32 v14, v107
    v_mov_b32 v15, v107
    v_mov_b32 v16, v107
    v_mov_b32 v17, v107
    v_mov_b32 v18, v107
    v_mov_b32 v19, v107
    v_mov_b32 v20, v107
    v_mov_b32 v21, v107
    v_mov_b32 v22, v107
    v_mov_b32 v23, v107
    v_mov_b32 v24, v107
    v_mov_b32 v25, v107
    v_mov_b32 v26, v107
    v_mov_b32 v27, v107
    v_mov_b32 v68, 0
    v_mov_b32 v69, 0
    v_mov_b32 v70, 0
    v_mov_b32 v71, 0
    v_mov_b32 v72, 0
    v_mov_b32 v73, 0
    v_mov_b32 v74, 0
    v_mov_b32 v75, 0
    v_mov_b32 v76, 0
    v_mov_b32 v77, 0
    v_mov_b32 v78, 0
    v_mov_b32 v79, 0
    v_mov_b32 v80, 0
    v_mov_b32 v81, 0
    v_mov_b32 v82, 0
    v_mov_b32 v83, 0
    v_mov_b32 v28, 0xdddddddd
    v_mov_b32 v60, 0
    v_mov_b32 v61, 0
    v_mov_b32 v62, 0
    v_mov_b32 v63, 0
    v_mov_b32 v64, 0
    v_mov_b32 v65, 0
    v_mov_b32 v66, 0
    v_mov_b32 v67, 0
    v_mov_b32 v107, 0x455ac000
    s_waitcnt lgkmcnt(0)
    s_barrier
L_att2:
    s_waitcnt vmcnt(0) lgkmcnt(0)
    s_barrier
    ds_read_b128 v[4:7], v102
    ds_read_b128 v[120:123], v103
    ds_read_b128 v[8:11], v100
    s_add_u32 m0, s47, 8192
    s_add_u32 s34, s57, 1
    s_and_b32 s34, s34, 3
    s_lshl_b32 s34, s34, 13
    s_add_u32 s34, s34, 15728640
    s_add_u32 s35, s34, 65536
    buffer_load_dwordx4 v3, s[24:27], s34 offen sc1 lds
    s_add_u32 m0, s47, 73728
    s_nop 0
    buffer_load_dwordx4 v3, s[24:27], s35 offen sc1 lds
    s_waitcnt lgkmcnt(0)
    v_readfirstlane_b32 s58, v120
    v_readfirstlane_b32 s59, v121
    v_mov_b32 v104, v122
    v_dot2_f32_bf16 v106, v4, v4, 0
    v_dot2_f32_bf16 v106, v5, v5, v106
    v_dot2_f32_bf16 v106, v6, v6, v106
    v_dot2_f32_bf16 v106, v7, v7, v106
    s_nop 2
    v_mov_b32 v105, v106
    s_nop 1
    v_permlane32_swap_b32 v106, v105
    v_add_f32 v106, v106, v105
    v_mul_f32 v104, v104, v106
    v_cmp_nle_f32 vcc, v104, v107
    s_add_u32 m0, s47, 16384
    s_add_u32 s34, s57, 2
    s_and_b32 s34, s34, 3
    s_lshl_b32 s34, s34, 13
    s_add_u32 s34, s34, 15728640
    s_add_u32 s35, s34, 65536
    buffer_load_dwordx4 v3, s[24:27], s34 offen sc1 lds
    s_add_u32 m0, s47, 81920
    s_nop 0
    buffer_load_dwordx4 v3, s[24:27], s35 offen sc1 lds
    s_add_u32 m0, s47, 24576
    s_add_u32 s34, s57, 3
    s_and_b32 s34, s34, 3
    s_lshl_b32 s34, s34, 13
    s_add_u32 s34, s34, 15728640
    s_add_u32 s35, s34, 65536
    buffer_load_dwordx4 v3, s[24:27], s34 offen sc1 lds
    s_add_u32 m0, s47, 90112
    s_nop 0
    buffer_load_dwordx4 v3, s[24:27], s35 offen sc1 lds
    s_cbranch_vccnz L_k2_slow
L_k2_start:
    s_waitcnt lgkmcnt(0)
    v_mfma_f32_32x32x16_bf16 v[36:51], v[8:11], v[4:7], 0
    ds_read_b128 v[8:11], v100 offset:1024
    s_mov_b64 exec, s[40:41]
    ds_read_b128 v[12:15], v101
    ds_read_b128 v[16:19], v101 offset:512
    s_mov_b64 exec, -1
    s_nop 7
L_k2_loop:
    s_bitcmp1_b32 s31, s36
    s_cbranch_scc1 L_k2_ev
L_k2_body:
    s_setprio 3
    v_exp_f32 v36, v36
    v_exp_f32 v37, v37
    v_exp_f32 v38, v38
    v_smfmac_f32_32x32x32_bf16 v[68:83], v[24:27], v[60:67], v28
    s_mov_b64 exec, s[40:41]
    ds_read_b128 v[20:23], v101 offset:1024
    ds_read_b128 v[24:27], v101 offset:1536
    s_mov_b64 exec, -1
    v_exp_f32 v39, v39
    v_exp_f32 v40, v40
    v_exp_f32 v41, v41
    v_exp_f32 v42, v42
    v_exp_f32 v43, v43
    s_waitcnt lgkmcnt(2)
    v_mfma_f32_32x32x16_bf16 v[52:67], v[8:11], v[4:7], 0
    ds_read_b128 v[8:11], v100 offset:2048
    v_exp_f32 v44, v44
    v_exp_f32 v45, v45
    v_exp_f32 v46, v46
    v_exp_f32 v47, v47
    v_exp_f32 v48, v48
    v_smfmac_f32_32x32x32_bf16 v[68:83], v[12:15], v[36:43], v28
    v_exp_f32 v49, v49
    v_exp_f32 v50, v50
    v_exp_f32 v51, v51
    s_setprio 2
    s_nop 0
    v_exp_f32 v52, v52
    v_exp_f32 v53, v53
    v_exp_f32 v54, v54
    v_smfmac_f32_32x32x32_bf16 v[68:83], v[16:19], v[44:51], v28
    s_mov_b64 exec, s[40:41]
    ds_read_b128 v[12:15], v101 offset:2048
    ds_read_b128 v[16:19], v101 offset:2560
    s_mov_b64 exec, -1
    v_exp_f32 v55, v55
    v_exp_f32 v56, v56
    v_exp_f32 v57, v57
    v_exp_f32 v58, v58
    v_exp_f32 v59, v59
    s_waitcnt lgkmcnt(2)
    v_mfma_f32_32x32x16_bf16 v[36:51], v[8:11], v[4:7], 0
    ds_read_b128 v[8:11], v100 offset:3072
    v_exp_f32 v60, v60
    v_exp_f32 v61, v61
    v_exp_f32 v62, v62
    v_exp_f32 v63, v63
    v_exp_f32 v64, v64
    v_smfmac_f32_32x32x32_bf16 v[68:83], v[20:23], v[52:59], v28
    v_exp_f32 v65, v65
    v_exp_f32 v66, v66
    v_exp_f32 v67, v67
    s_setprio 1
    s_nop 0
    v_exp_f32 v36, v36
    v_exp_f32 v37, v37
    v_exp_f32 v38, v38
    v_smfmac_f32_32x32x32_bf16 v[68:83], v[24:27], v[60:67], v28
    s_mov_b64 exec, s[40:41]
    ds_read_b128 v[20:23], v101 offset:3072
    ds_read_b128 v[24:27], v101 offset:3584
    s_mov_b64 exec, -1
    v_exp_f32 v39, v39
    v_exp_f32 v40, v40
    v_exp_f32 v41, v41
    v_exp_f32 v42, v42
    v_exp_f32 v43, v43
    s_waitcnt lgkmcnt(2)
    v_mfma_f32_32x32x16_bf16 v[52:67], v[8:11], v[4:7], 0
    ds_read_b128 v[8:11], v100 offset:4096
    v_exp_f32 v44, v44
    v_exp_f32 v45, v45
    v_exp_f32 v46, v46
    v_exp_f32 v47, v47
    v_exp_f32 v48, v48
    v_smfmac_f32_32x32x32_bf16 v[68:83], v[12:15], v[36:43], v28
    v_exp_f32 v49, v49
    v_exp_f32 v50, v50
    v_exp_f32 v51, v51
    s_setprio 0
    s_nop 0
    v_exp_f32 v52, v52
    v_exp_f32 v53, v53
    v_exp_f32 v54, v54
    v_smfmac_f32_32x32x32_bf16 v[68:83], v[16:19], v[44:51], v28
    s_mov_b64 exec, s[40:41]
    ds_read_b128 v[12:15], v101 offset:4096
    ds_read_b128 v[16:19], v101 offset:4608
    s_mov_b64 exec, -1
    v_exp_f32 v55, v55
    v_exp_f32 v56, v56
    v_exp_f32 v57, v57
    v_exp_f32 v58, v58
    v_exp_f32 v59, v59
    s_waitcnt lgkmcnt(2)
    v_mfma_f32_32x32x16_bf16 v[36:51], v[8:11], v[4:7], 0
    ds_read_b128 v[8:11], v100 offset:5120
    v_exp_f32 v60, v60
    v_exp_f32 v61, v61
    v_exp_f32 v62, v62
    v_exp_f32 v63, v63
    v_exp_f32 v64, v64
    v_smfmac_f32_32x32x32_bf16 v[68:83], v[20:23], v[52:59], v28
    v_exp_f32 v65, v65
    v_exp_f32 v66, v66
    v_exp_f32 v67, v67
    v_add_u32 v100, 4096, v100
    v_add_u32 v101, 4096, v101
    s_add_u32 s36, s36, 1
    s_cmp_lt_u32 s36, 8
    s_cbranch_scc1 L_k2_loop
L_k2_done:
    v_smfmac_f32_32x32x32_bf16 v[68:83], v[24:27], v[60:67], v28
    s_setprio 0
    s_waitcnt lgkmcnt(0)
    s_mul_i32 s45, s38, 2304
    s_add_u32 s45, s45, 131072
    v_add_u32 v103, s45, v2
    v_lshlrev_b32 v104, 2, v1
    v_add_u32 v104, s45, v104
    v_mov_b32 v107, 150016
    s_lshl_b32 s35, s38, 2
    s_add_u32 s35, s35, 150144
    v_mov_b32 v102, s35
    s_cmp_eq_u32 s39, 0
    s_cbranch_scc1 L_k2_give
    s_mov_b32 s60, 0
L_k2_mw:
    ds_read_b32 v105, v102
    ds_read_b32 v106, v107
    ds_read_b128 v[36:39], v103
    ds_read_b128 v[40:43], v103 offset:1024
    ds_read_b32 v44, v104 offset:2048
    s_lshl_b32 s34, s29, 13
    s_add_u32 s34, s34, 19922944
    s_lshl_b32 s35, s32, 12
    s_add_u32 s34, s34, s35
    s_lshl_b32 s35, s30, 9
    s_add_u32 s34, s34, s35
    s_lshr_b32 s35, s38, 1
    s_lshl_b32 s35, s35, 7
    s_add_u32 s34, s34, s35
    s_add_u32 s33, s46, 2097152
    s_add_u32 s60, s60, 1
    s_waitcnt lgkmcnt(0)
    v_readfirstlane_b32 s63, v106
    v_readfirstlane_b32 s35, v105
    s_cmp_gt_u32 s60, 0x400000
    s_cbranch_scc1 L_k2_mok
    s_cmp_eq_u32 s63, 2
    s_cbranch_scc1 L_k2_mw
    s_cmp_eq_u32 s35, 0
    s_cbranch_scc1 L_k2_mw
L_k2_mok:
    v_add_f32 v68, v68, v36
    v_add_f32 v69, v69, v37
    v_add_f32 v70, v70, v38
    v_add_f32 v71, v71, v39
    v_add_f32 v72, v72, v40
    v_add_f32 v73, v73, v41
    v_add_f32 v74, v74, v42
    v_add_f32 v75, v75, v43
    v_add_f32 v76, v76, v44
    v_mov_b32 v104, v76
    s_nop 1
    v_permlane32_swap_b32 v76, v104
    v_rcp_f32 v104, v76
    s_nop 0
    v_mul_f32 v68, v104, v68
    v_mul_f32 v69, v104, v69
    v_mul_f32 v70, v104, v70
    v_mul_f32 v71, v104, v71
    v_mul_f32 v72, v104, v72
    v_mul_f32 v73, v104, v73
    v_mul_f32 v74, v104, v74
    v_mul_f32 v75, v104, v75
    v_cvt_pk_bf16_f32 v28, v68, v69
    v_cvt_pk_bf16_f32 v29, v70, v71
    v_cvt_pk_bf16_f32 v30, v72, v73
    v_cvt_pk_bf16_f32 v31, v74, v75
    buffer_store_dwordx4 v[28:31], v2, s[24:27], s33 offen sc1
    s_waitcnt vmcnt(0)
    v_mov_b32 v12, s58
    v_mov_b32 v13, s59
    v_mov_b32 v15, 0
    s_mov_b64 exec, 1
    s_cmp_lg_u32 s63, 0
    s_cbranch_scc1 L_sequential_preLN__grouped_kv_mqa__mixer_gmlp__prompt_kernel_hs_1
    buffer_store_dwordx2 v[12:13], v15, s[24:27], s34 offen sc1
    s_branch L_sequential_preLN__grouped_kv_mqa__mixer_gmlp__prompt_kernel_hs_2
L_sequential_preLN__grouped_kv_mqa__mixer_gmlp__prompt_kernel_hs_1:
    buffer_store_dwordx2 v[12:13], v15, s[24:27], s34 offen
L_sequential_preLN__grouped_kv_mqa__mixer_gmlp__prompt_kernel_hs_2:
    s_mov_b64 exec, -1
    s_cmp_lt_u32 s28, 12
    s_cbranch_scc1 L_kb_loader
    s_endpgm
L_k2_ev:
    s_cmp_ge_u32 s36, 6
    s_cbranch_scc1 L_k2_cnt
    s_cmp_eq_u32 s36, 4
    s_cbranch_scc1 L_k2_st4
    s_cmp_eq_u32 s36, 3
    s_cbranch_scc1 L_k2_st3
    s_cmp_eq_u32 s36, 1
    s_cbranch_scc1 L_k2_st1
    s_setprio 2
    s_branch L_k2_ret
L_k2_st1:
    s_cmp_eq_u32 s42, 1
    s_cbranch_scc0 L_k2_st1c
    s_waitcnt vmcnt(0)
    s_barrier
L_k2_st1c:
    s_cmp_eq_u32 s62, 0
    s_cbranch_scc1 L_nopk
    s_add_u32 m0, s45, 0
    s_nop 0
    buffer_load_dwordx4 v113, s[20:23], s50 offen lds
    s_add_u32 s50, s50, s51
    s_add_u32 m0, s45, 1024
    s_nop 0
    buffer_load_dwordx4 v113, s[20:23], s50 offen lds
    s_add_u32 s50, s50, s51
    s_add_u32 m0, s45, 2048
    s_nop 0
    buffer_load_dwordx4 v113, s[20:23], s50 offen lds
    s_add_u32 s50, s50, s51
    s_add_u32 m0, s45, 3072
    s_nop 0
    buffer_load_dwordx4 v113, s[20:23], s50 offen lds
    s_add_u32 s50, s50, s51
    s_add_u32 m0, s45, 4096
    s_nop 0
    buffer_load_dwordx4 v113, s[20:23], s50 offen lds
    s_add_u32 s50, s50, s51
    s_add_u32 m0, s45, 5120
    s_nop 0
    buffer_load_dwordx4 v113, s[20:23], s50 offen lds
    s_add_u32 s50, s50, s51
    s_add_u32 m0, s45, 6144
    s_nop 0
    buffer_load_dwordx4 v113, s[20:23], s50 offen lds
    s_add_u32 s50, s50, s51
    s_add_u32 m0, s45, 7168
    s_nop 0
    buffer_load_dwordx4 v113, s[20:23], s50 offen lds
    s_add_u32 s50, s50, s51
    s_branch L_k2_ret
L_nopk:
    s_lshr_b32 s34, s28, 2
    s_cmp_eq_u32 s34, 1
    s_cbranch_scc0 L_k2_ret
    s_load_dwordx2 s[52:53], s[0:1], 56
    s_lshr_b32 s61, s2, 3
    s_lshl_b32 s61, s61, 2
    s_add_u32 s61, s61, s3
    v_lshlrev_b32 v108, 7, v1
    s_and_b32 s37, s2, 7
    s_lshl_b32 s37, s37, 20
    s_lshl_b32 s61, s61, 13
    s_add_u32 s37, s37, s61
    s_mov_b32 s54, 8388608
    s_mov_b32 s55, 0x00020000
    s_waitcnt lgkmcnt(0)
    buffer_load_dword v120, v108, s[52:55], s37 offen
    s_cmp_eq_u32 s28, 4
    s_cbranch_scc0 L_k2_ret
    s_lshr_b32 s34, s29, 1
    s_lshl_b32 s34, s34, 7
    s_and_b32 s35, s29, 1
    s_lshl_b32 s35, s35, 3
    s_add_u32 s34, s34, s35
    s_add_u32 s34, s34, s30
    s_lshl_b32 s34, s34, 7
    s_add_u32 s34, s34, 16252928
    v_mov_b32 v112, -1
    v_mov_b32 v113, -1
    v_mov_b32 v114, -1
    v_mov_b32 v115, -1
    v_lshrrev_b32 v116, 3, v1
    v_lshlrev_b32 v116, 11, v116
    v_and_b32 v117, 7, v1
    v_lshl_add_u32 v116, v117, 4, v116
    buffer_store_dwordx4 v[112:115], v116, s[24:27], s34 offen sc1
    s_branch L_k2_ret
L_k2_cnt:
L_k2_cnt2:
    s_waitcnt lgkmcnt(0)
    s_mov_b64 exec, 1
    ds_add_u32 v118, v119
    s_mov_b64 exec, -1
    v_add_u32 v118, 4, v118
    s_branch L_k2_ret
L_k2_st4:
    s_cmp_eq_u32 s62, 0
    s_cbranch_scc1 L_k2_cnt2
    v_mov_b32 v112, s58
    v_mov_b32 v113, s59
    v_mov_b32 v114, 0
    s_waitcnt vmcnt(0)
    s_mov_b64 exec, 1
    buffer_store_dwordx2 v[112:113], v114, s[24:27], s62 offen sc1
    s_mov_b64 exec, -1
    s_branch L_k2_cnt2
L_k2_st3:
    s_waitcnt vmcnt(0)
    s_cmp_lg_u32 s62, 0
    s_cbranch_scc1 L_k2_pk
    s_and_b32 s34, s29, 1
    s_lshl_b32 s34, s34, 3
    s_add_u32 s34, s34, s30
    s_lshl_b32 s34, s34, 7
    s_add_u32 s34, s34, s63
    s_getreg_b32 s60, hwreg(HW_REG_XCC_ID, 0, 4)
    s_add_u32 s60, s60, s59
    v_mov_b32 v108, s58
    v_mov_b32 v109, s60
    v_mov_b32 v110, 0
    s_mov_b64 exec, 1
    buffer_store_dwordx2 v[108:109], v110, s[24:27], s34 offen sc1
    s_mov_b64 exec, -1
    s_branch L_k2_ret
L_k2_pk:
    s_mov_b32 s34, 0x3f803f80
    s_add_u32 s35, s48, 4096
    v_mov_b32 v110, 0
    v_mov_b32 v111, 0
    ds_read_b64_tr_b16 v[120:121], v108 offset:0
    ds_read_b64_tr_b16 v[122:123], v109 offset:0
    ds_read_b64_tr_b16 v[124:125], v108 offset:1024
    ds_read_b64_tr_b16 v[126:127], v109 offset:1024
    s_waitcnt lgkmcnt(0)
    buffer_store_dwordx4 v[120:123], v2, s[24:27], s48 offen offset:0 sc1
    buffer_store_dwordx4 v[124:127], v2, s[24:27], s48 offen offset:1024 sc1
    v_dot2_f32_bf16 v110, v120, s34, v110
    v_dot2_f32_bf16 v111, v121, s34, v111
    v_dot2_f32_bf16 v110, v122, s34, v110
    v_dot2_f32_bf16 v111, v123, s34, v111
    v_dot2_f32_bf16 v110, v124, s34, v110
    v_dot2_f32_bf16 v111, v125, s34, v111
    v_dot2_f32_bf16 v110, v126, s34, v110
    v_dot2_f32_bf16 v111, v127, s34, v111
    ds_read_b64_tr_b16 v[120:121], v108 offset:2048
    ds_read_b64_tr_b16 v[122:123], v109 offset:2048
    ds_read_b64_tr_b16 v[124:125], v108 offset:3072
    ds_read_b64_tr_b16 v[126:127], v109 offset:3072
    s_waitcnt lgkmcnt(0)
    buffer_store_dwordx4 v[120:123], v2, s[24:27], s48 offen offset:2048 sc1
    buffer_store_dwordx4 v[124:127], v2, s[24:27], s48 offen offset:3072 sc1
    v_dot2_f32_bf16 v110, v120, s34, v110
    v_dot2_f32_bf16 v111, v121, s34, v111
    v_dot2_f32_bf16 v110, v122, s34, v110
    v_dot2_f32_bf16 v111, v123, s34, v111
    v_dot2_f32_bf16 v110, v124, s34, v110
    v_dot2_f32_bf16 v111, v125, s34, v111
    v_dot2_f32_bf16 v110, v126, s34, v110
    v_dot2_f32_bf16 v111, v127, s34, v111
    ds_read_b64_tr_b16 v[120:121], v108 offset:4096
    ds_read_b64_tr_b16 v[122:123], v109 offset:4096
    ds_read_b64_tr_b16 v[124:125], v108 offset:5120
    ds_read_b64_tr_b16 v[126:127], v109 offset:5120
    s_waitcnt lgkmcnt(0)
    buffer_store_dwordx4 v[120:123], v2, s[24:27], s35 offen offset:0 sc1
    buffer_store_dwordx4 v[124:127], v2, s[24:27], s35 offen offset:1024 sc1
    v_dot2_f32_bf16 v110, v120, s34, v110
    v_dot2_f32_bf16 v111, v121, s34, v111
    v_dot2_f32_bf16 v110, v122, s34, v110
    v_dot2_f32_bf16 v111, v123, s34, v111
    v_dot2_f32_bf16 v110, v124, s34, v110
    v_dot2_f32_bf16 v111, v125, s34, v111
    v_dot2_f32_bf16 v110, v126, s34, v110
    v_dot2_f32_bf16 v111, v127, s34, v111
    ds_read_b64_tr_b16 v[120:121], v108 offset:6144
    ds_read_b64_tr_b16 v[122:123], v109 offset:6144
    ds_read_b64_tr_b16 v[124:125], v108 offset:7168
    ds_read_b64_tr_b16 v[126:127], v109 offset:7168
    s_waitcnt lgkmcnt(0)
    buffer_store_dwordx4 v[120:123], v2, s[24:27], s35 offen offset:2048 sc1
    buffer_store_dwordx4 v[124:127], v2, s[24:27], s35 offen offset:3072 sc1
    v_dot2_f32_bf16 v110, v120, s34, v110
    v_dot2_f32_bf16 v111, v121, s34, v111
    v_dot2_f32_bf16 v110, v122, s34, v110
    v_dot2_f32_bf16 v111, v123, s34, v111
    v_dot2_f32_bf16 v110, v124, s34, v110
    v_dot2_f32_bf16 v111, v125, s34, v111
    v_dot2_f32_bf16 v110, v126, s34, v110
    v_dot2_f32_bf16 v111, v127, s34, v111
    s_cmp_eq_u32 s49, 0
    s_cbranch_scc1 L_k2_ret
    s_nop 0
    v_add_f32 v110, v110, v111
    v_mov_b32 v111, v110
    s_nop 1
    v_permlane32_swap_b32 v110, v111
    v_add_f32 v110, v110, v111
    v_mov_b32 v111, v110
    s_nop 1
    v_permlane16_swap_b32 v110, v111
    v_add_f32 v110, v110, v111
    v_lshlrev_b32 v111, 2, v1
    s_mov_b64 exec, 0xffff
    buffer_store_dword v110, v111, s[24:27], s49 offen sc1
    s_mov_b64 exec, -1
    s_branch L_k2_ret
L_k2_ret:
    s_cmp_eq_u32 s42, 1
    s_cbranch_scc1 L_k2_body
    s_branch L_k2_body_s
L_k2_slow:
    s_waitcnt vmcnt(0)
    s_barrier
    s_mov_b32 s42, 99
    v_mov_b32 v104, 0xff800000
    v_mov_b32 v103, v2
    s_mov_b32 s37, 0
L_k2_mx:
    ds_read_b128 v[8:11], v103
    s_waitcnt lgkmcnt(0)
    v_mfma_f32_32x32x16_bf16 v[36:51], v[8:11], v[4:7], 0
    v_add_u32 v103, 1024, v103
    s_nop 10
    v_max3_f32 v104, v36, v37, v104
    v_max3_f32 v104, v38, v39, v104
    v_max3_f32 v104, v40, v41, v104
    v_max3_f32 v104, v42, v43, v104
    v_max3_f32 v104, v44, v45, v104
    v_max3_f32 v104, v46, v47, v104
    v_max3_f32 v104, v48, v49, v104
    v_max3_f32 v104, v50, v51, v104
    s_add_u32 s37, s37, 1
    s_cmp_lt_u32 s37, 64
    s_cbranch_scc1 L_k2_mx
    v_mov_b32 v105, v104
    s_nop 1
    v_permlane32_swap_b32 v104, v105
    v_max_f32 v104, v104, v105
    v_sub_f32 v84, 0, v104
    v_sub_f32 v85, 0, v104
    v_sub_f32 v86, 0, v104
    v_sub_f32 v87, 0, v104
    v_sub_f32 v88, 0, v104
    v_sub_f32 v89, 0, v104
    v_sub_f32 v90, 0, v104
    v_sub_f32 v91, 0, v104
    v_sub_f32 v92, 0, v104
    v_sub_f32 v93, 0, v104
    v_sub_f32 v94, 0, v104
    v_sub_f32 v95, 0, v104
    v_sub_f32 v96, 0, v104
    v_sub_f32 v97, 0, v104
    v_sub_f32 v98, 0, v104
    v_sub_f32 v99, 0, v104
    ds_read_b128 v[8:11], v100
L_k2_start_s:
    s_waitcnt lgkmcnt(0)
    v_mfma_f32_32x32x16_bf16 v[36:51], v[8:11], v[4:7], v[84:99]
    ds_read_b128 v[8:11], v100 offset:1024
    s_mov_b64 exec, s[40:41]
    ds_read_b128 v[12:15], v101
    ds_read_b128 v[16:19], v101 offset:512
    s_mov_b64 exec, -1
    s_nop 7
L_k2_loop_s:
    s_bitcmp1_b32 s31, s36
    s_cbranch_scc1 L_k2_ev
L_k2_body_s:
    s_setprio 3
    v_exp_f32 v36, v36
    v_exp_f32 v37, v37
    v_exp_f32 v38, v38
    v_smfmac_f32_32x32x32_bf16 v[68:83], v[24:27], v[60:67], v28
    s_mov_b64 exec, s[40:41]
    ds_read_b128 v[20:23], v101 offset:1024
    ds_read_b128 v[24:27], v101 offset:1536
    s_mov_b64 exec, -1
    v_exp_f32 v39, v39
    v_exp_f32 v40, v40
    v_exp_f32 v41, v41
    v_exp_f32 v42, v42
    v_exp_f32 v43, v43
    s_waitcnt lgkmcnt(2)
    v_mfma_f32_32x32x16_bf16 v[52:67], v[8:11], v[4:7], v[84:99]
    ds_read_b128 v[8:11], v100 offset:2048
    v_exp_f32 v44, v44
    v_exp_f32 v45, v45
    v_exp_f32 v46, v46
    v_exp_f32 v47, v47
    v_exp_f32 v48, v48
    v_smfmac_f32_32x32x32_bf16 v[68:83], v[12:15], v[36:43], v28
    v_exp_f32 v49, v49
    v_exp_f32 v50, v50
    v_exp_f32 v51, v51
    s_setprio 2
    s_nop 0
    v_exp_f32 v52, v52
    v_exp_f32 v53, v53
    v_exp_f32 v54, v54
    v_smfmac_f32_32x32x32_bf16 v[68:83], v[16:19], v[44:51], v28
    s_mov_b64 exec, s[40:41]
    ds_read_b128 v[12:15], v101 offset:2048
    ds_read_b128 v[16:19], v101 offset:2560
    s_mov_b64 exec, -1
    v_exp_f32 v55, v55
    v_exp_f32 v56, v56
    v_exp_f32 v57, v57
    v_exp_f32 v58, v58
    v_exp_f32 v59, v59
    s_waitcnt lgkmcnt(2)
    v_mfma_f32_32x32x16_bf16 v[36:51], v[8:11], v[4:7], v[84:99]
    ds_read_b128 v[8:11], v100 offset:3072
    v_exp_f32 v60, v60
    v_exp_f32 v61, v61
    v_exp_f32 v62, v62
    v_exp_f32 v63, v63
    v_exp_f32 v64, v64
    v_smfmac_f32_32x32x32_bf16 v[68:83], v[20:23], v[52:59], v28
    v_exp_f32 v65, v65
    v_exp_f32 v66, v66
    v_exp_f32 v67, v67
    s_setprio 1
    s_nop 0
    v_exp_f32 v36, v36
    v_exp_f32 v37, v37
    v_exp_f32 v38, v38
    v_smfmac_f32_32x32x32_bf16 v[68:83], v[24:27], v[60:67], v28
    s_mov_b64 exec, s[40:41]
    ds_read_b128 v[20:23], v101 offset:3072
    ds_read_b128 v[24:27], v101 offset:3584
    s_mov_b64 exec, -1
    v_exp_f32 v39, v39
    v_exp_f32 v40, v40
    v_exp_f32 v41, v41
    v_exp_f32 v42, v42
    v_exp_f32 v43, v43
    s_waitcnt lgkmcnt(2)
    v_mfma_f32_32x32x16_bf16 v[52:67], v[8:11], v[4:7], v[84:99]
    ds_read_b128 v[8:11], v100 offset:4096
    v_exp_f32 v44, v44
    v_exp_f32 v45, v45
    v_exp_f32 v46, v46
    v_exp_f32 v47, v47
    v_exp_f32 v48, v48
    v_smfmac_f32_32x32x32_bf16 v[68:83], v[12:15], v[36:43], v28
    v_exp_f32 v49, v49
    v_exp_f32 v50, v50
    v_exp_f32 v51, v51
    s_setprio 0
    s_nop 0
    v_exp_f32 v52, v52
    v_exp_f32 v53, v53
    v_exp_f32 v54, v54
    v_smfmac_f32_32x32x32_bf16 v[68:83], v[16:19], v[44:51], v28
    s_mov_b64 exec, s[40:41]
    ds_read_b128 v[12:15], v101 offset:4096
    ds_read_b128 v[16:19], v101 offset:4608
    s_mov_b64 exec, -1
    v_exp_f32 v55, v55
    v_exp_f32 v56, v56
    v_exp_f32 v57, v57
    v_exp_f32 v58, v58
    v_exp_f32 v59, v59
    s_waitcnt lgkmcnt(2)
    v_mfma_f32_32x32x16_bf16 v[36:51], v[8:11], v[4:7], v[84:99]
    ds_read_b128 v[8:11], v100 offset:5120
    v_exp_f32 v60, v60
    v_exp_f32 v61, v61
    v_exp_f32 v62, v62
    v_exp_f32 v63, v63
    v_exp_f32 v64, v64
    v_smfmac_f32_32x32x32_bf16 v[68:83], v[20:23], v[52:59], v28
    v_exp_f32 v65, v65
    v_exp_f32 v66, v66
    v_exp_f32 v67, v67
    v_add_u32 v100, 4096, v100
    v_add_u32 v101, 4096, v101
    s_add_u32 s36, s36, 1
    s_cmp_lt_u32 s36, 8
    s_cbranch_scc1 L_k2_loop_s
    s_nop 1
    s_branch L_k2_done
L_k2_give:
    s_load_dwordx2 s[4:5], s[0:1], 0
    s_cmp_eq_u32 s28, 4
    s_cbranch_scc0 L_kb_nochk
    v_and_b32 v110, 15, v1
    v_lshlrev_b32 v110, 7, v110
    s_mov_b32 s60, 0
L_xc_b:
    buffer_load_dwordx2 v[108:109], v110, s[24:27], s63 offen sc1
    s_add_u32 s60, s60, 1
    s_waitcnt vmcnt(0)
    v_subrev_u32 v109, s59, v109
    v_xor_b32 v108, s58, v108
    v_lshrrev_b32 v106, 4, v109
    v_or_b32 v108, v108, v106
    v_cmp_ne_u32 vcc, 0, v108
    s_cmp_gt_u32 s60, 0x40000
    s_cbranch_scc1 L_xcok_b
    s_cbranch_vccnz L_xc_b
L_xcok_b:
    v_readfirstlane_b32 s60, v109
    s_nop 1
    v_cmp_ne_u32 vcc, s60, v109
    s_nop 0
    s_cmp_eq_u64 vcc, 0
    s_cselect_b32 s60, 1, 0
    v_mov_b32 v106, s60
    ds_write_b32 v107, v106
L_kb_nochk:
    s_and_b32 s31, s29, 1
    s_lshl_b32 s31, s31, 3
    s_add_u32 s31, s31, s30
    s_mul_i32 s31, s31, 3
    s_min_u32 s31, s31, 40
    s_lshl_b32 s34, s31, 1
    s_lshl_b32 s35, s30, 3
    s_add_u32 s35, s35, 172
    s_mul_i32 s37, s30, 12
    s_add_u32 s37, s37, 216
    s_sub_u32 s34, s34, 8
    v_and_b32 v108, 31, v1
    v_add_u32 v109, s35, v108
    v_add_u32 v110, s34, v108
    v_cmp_lt_u32 vcc, 7, v108
    s_nop 1
    v_cndmask_b32 v109, v109, v110, vcc
    v_add_u32 v110, 80, v110
    v_cmp_lt_u32 vcc, 13, v108
    s_nop 1
    v_cndmask_b32 v109, v109, v110, vcc
    v_add_u32 v110, s37, v108
    v_cmp_lt_u32 vcc, 19, v108
    s_nop 1
    v_cndmask_b32 v109, v109, v110, vcc
    v_lshlrev_b32 v15, 7, v109
    s_mov_b32 s37, 20742144
    s_mov_b32 exec_hi, 0
    s_mov_b32 s60, 0
L_poll_p:
    buffer_load_dwordx2 v[12:13], v15, s[24:27], s37 offen sc1
    s_add_u32 s60, s60, 1
    s_waitcnt vmcnt(0)
    v_xor_b32 v12, s58, v12
    v_xor_b32 v13, s59, v13
    v_or_b32 v12, v12, v13
    v_cmp_ne_u32 vcc, 0, v12
    s_cmp_gt_u32 s60, 0x40000
    s_cbranch_scc1 L_pollok_p
    s_cbranch_vccz L_pollok_p
    s_sleep 2
    s_branch L_poll_p
L_pollok_p:
    s_mov_b64 exec, -1
    s_lshl_b32 s40, s31, 14
    s_add_u32 s40, s40, 20971520
    s_cmp_ge_u32 s28, 4
    s_cbranch_scc1 L_gv_pf
    s_mul_i32 s35, s28, 3072
    s_add_u32 m0, s35, 151552
    s_add_u32 s35, s35, s40
    buffer_load_dwordx4 v2, s[24:27], s35 offen offset:0 sc1 lds
    buffer_load_dwordx4 v2, s[24:27], s35 offen offset:1024 sc1 lds
    buffer_load_dwordx4 v2, s[24:27], s35 offen offset:2048 sc1 lds
    s_mul_i32 s35, s28, 12288
    s_add_u32 s35, s35, s40
    s_add_u32 s35, s35, 704512
    v_lshlrev_b32 v108, 7, v1
    buffer_load_dword v117, v108, s[24:27], s35 offen sc1
    v_and_b32 v109, 31, v1
    v_lshlrev_b32 v109, 7, v109
    s_add_u32 s35, s35, 8192
    buffer_load_dword v117, v109, s[24:27], s35 offen sc1
    s_mul_i32 s35, s28, 9216
    s_add_u32 s35, s35, s40
    s_add_u32 s35, s35, 12288
    buffer_load_dword v117, v108, s[24:27], s35 offen sc1
    v_and_b32 v109, 7, v1
    v_lshlrev_b32 v109, 7, v109
    s_add_u32 s35, s35, 8192
    buffer_load_dword v117, v109, s[24:27], s35 offen sc1
    s_branch L_gv_c6
L_gv_pf:
L_gv_c6:
    v_mov_b32 v108, 150080
    s_mov_b32 s60, 0
L_cw_6:
    ds_read_b32 v109, v108
    s_add_u32 s60, s60, 1
    s_waitcnt lgkmcnt(0)
    v_readfirstlane_b32 s34, v109
    s_cmp_gt_u32 s60, 0x400000
    s_cbranch_scc1 L_cwok_6
    s_cmp_ge_u32 s34, 16
    s_cbranch_scc1 L_cwok_6
    s_sleep 2
    s_branch L_cw_6
L_cwok_6:
    ds_write_b128 v103, v[68:71]
    ds_write_b128 v103, v[72:75] offset:1024
    ds_write_b32 v104, v76 offset:2048
    ds_write_b32 v102, v119
    s_lshl_b32 s35, s30, 16
    s_lshl_b32 s37, s28, 13
    s_add_u32 s35, s35, s37
    s_add_u32 s35, s35, 22544384
    s_lshr_b32 s37, s28, 1
    s_lshl_b32 s37, s37, 15
    s_lshl_b32 s41, s32, 13
    s_add_u32 s41, s41, s37
    s_mov_b32 m0, s41
    s_nop 0
    buffer_load_dwordx4 v2, s[24:27], s35 offen offset:0 sc1 lds
    buffer_load_dwordx4 v2, s[24:27], s35 offen offset:1024 sc1 lds
    buffer_load_dwordx4 v2, s[24:27], s35 offen offset:2048 sc1 lds
    buffer_load_dwordx4 v2, s[24:27], s35 offen offset:3072 sc1 lds
    s_add_u32 m0, s41, 4096
    s_add_u32 s35, s35, 4096
    buffer_load_dwordx4 v2, s[24:27], s35 offen offset:0 sc1 lds
    buffer_load_dwordx4 v2, s[24:27], s35 offen offset:1024 sc1 lds
    buffer_load_dwordx4 v2, s[24:27], s35 offen offset:2048 sc1 lds
    buffer_load_dwordx4 v2, s[24:27], s35 offen offset:3072 sc1 lds
    v_lshrrev_b32 v8, 4, v1
    v_lshrrev_b32 v9, 5, v1
    v_lshrrev_b32 v10, 2, v1
    v_and_b32 v10, 3, v10
    v_and_b32 v11, 3, v1
    v_mov_b32 v108, 150084
    s_mov_b32 s60, 0
L_cw_7:
    ds_read_b32 v109, v108
    s_add_u32 s60, s60, 1
    s_waitcnt lgkmcnt(0)
    v_readfirstlane_b32 s34, v109
    s_cmp_gt_u32 s60, 0x400000
    s_cbranch_scc1 L_cwok_7
    s_cmp_ge_u32 s34, 16
    s_cbranch_scc1 L_cwok_7
    s_sleep 2
    s_branch L_cw_7
L_cwok_7:
    s_lshl_b32 s35, s28, 12
    s_add_u32 s35, s35, s40
    s_add_u32 s35, s35, 704512
    s_lshl_b32 s41, s32, 12
    s_add_u32 s41, s41, s37
    s_add_u32 m0, s41, 16384
    s_nop 0
    buffer_load_dwordx4 v2, s[24:27], s35 offen offset:0 sc1 lds
    buffer_load_dwordx4 v2, s[24:27], s35 offen offset:1024 sc1 lds
    buffer_load_dwordx4 v2, s[24:27], s35 offen offset:2048 sc1 lds
    buffer_load_dwordx4 v2, s[24:27], s35 offen offset:3072 sc1 lds
    s_lshl_b32 s33, s29, 13
    s_add_u32 s33, s33, 19922944
    s_and_b32 s35, s28, 2
    s_lshl_b32 s35, s35, 11
    s_add_u32 s33, s33, s35
    s_and_b32 s35, s28, 4
    s_lshl_b32 s35, s35, 9
    s_add_u32 s33, s33, s35
    s_lshr_b32 s61, s28, 2
    s_lshl_b32 s36, s29, 2
    s_add_u32 s36, s36, s3
    s_lshl_b32 s37, s30, 1
    s_add_u32 s37, s37, s61
    v_and_b32 v14, 15, v1
    v_lshlrev_b32 v3, 10, v14
    v_lshl_add_u32 v3, v8, 3, v3
    s_lshl_b32 s44, s36, 14
    s_lshl_b32 s45, s37, 6
    s_add_u32 s44, s44, s45
    s_mov_b32 s16, s4
    s_mov_b32 s17, s5
    s_mov_b32 s18, 0x200000
    s_mov_b32 s19, 0x00020000
    buffer_load_dwordx2 v[96:97], v3, s[16:19], s44 offen
    buffer_load_dwordx2 v[98:99], v3, s[16:19], s44 offen offset:32
    s_lshl_b32 s45, s61, 13
    v_add_u32 v4, s45, v2
    v_add_u32 v5, 65536, v4
    v_lshrrev_b32 v12, 1, v8
    v_lshlrev_b32 v3, 10, v12
    v_and_b32 v12, 1, v8
    v_lshl_add_u32 v3, v12, 9, v3
    v_and_b32 v12, 15, v1
    v_lshl_add_u32 v3, v12, 4, v3
    s_lshl_b32 s60, s32, 8
    v_add_u32 v3, s60, v3
    s_lshr_b32 s46, s36, 1
    s_lshl_b32 s46, s46, 15
    s_lshl_b32 s47, s61, 14
    s_add_u32 s46, s46, s47
    s_add_u32 s46, s46, 2097152
    v_mov_b32 v16, 0
    v_mov_b32 v17, 0
    v_mov_b32 v18, 0
    v_mov_b32 v19, 0
    v_mov_b32 v20, 0
    v_mov_b32 v21, 0
    v_mov_b32 v22, 0
    v_mov_b32 v23, 0
    v_mov_b32 v24, 0
    v_mov_b32 v25, 0
    v_mov_b32 v26, 0
    v_mov_b32 v27, 0
    v_mov_b32 v28, 0
    v_mov_b32 v29, 0
    v_mov_b32 v30, 0
    v_mov_b32 v31, 0
    s_mov_b32 s60, 0
L_gv_fw:
    ds_read_b32 v106, v107
    s_add_u32 s60, s60, 1
    s_waitcnt lgkmcnt(0)
    v_readfirstlane_b32 s63, v106
    s_cmp_gt_u32 s60, 0x400000
    s_cbranch_scc1 L_gv_fok
    s_cmp_eq_u32 s63, 2
    s_cbranch_scc1 L_gv_fw
L_gv_fok:
    s_waitcnt vmcnt(0)
    s_barrier
    ds_read_b128 v[32:35], v4 offset:0
    ds_read_b128 v[36:39], v4 offset:32768
    ds_read_b128 v[40:43], v5 offset:0
    ds_read_b128 v[44:47], v5 offset:32768
    v_lshlrev_b32 v15, 7, v1
    s_mov_b64 exec, 0xffff
    s_mov_b32 s60, 0
L_poll_o:
    buffer_load_dwordx2 v[12:13], v15, s[24:27], s33 offen sc1
    s_add_u32 s60, s60, 1
    s_waitcnt vmcnt(0)
    v_xor_b32 v12, s58, v12
    v_xor_b32 v13, s59, v13
    v_or_b32 v12, v12, v13
    v_cmp_ne_u32 vcc, 0, v12
    s_cmp_gt_u32 s60, 0x40000
    s_cbranch_scc1 L_pollok_o
    s_cbranch_vccz L_pollok_o
    s_sleep 2
    s_branch L_poll_o
L_pollok_o:
    s_mov_b64 exec, -1
    s_add_u32 s47, s46, 0
    buffer_load_dwordx4 v[64:67], v3, s[24:27], s47 offen offset:0 sc1
    buffer_load_dwordx4 v[68:71], v3, s[24:27], s47 offen offset:2048 sc1
    s_add_u32 s47, s46, 4096
    buffer_load_dwordx4 v[72:75], v3, s[24:27], s47 offen offset:0 sc1
    buffer_load_dwordx4 v[76:79], v3, s[24:27], s47 offen offset:2048 sc1
    s_add_u32 s47, s46, 8192
    buffer_load_dwordx4 v[80:83], v3, s[24:27], s47 offen offset:0 sc1
    buffer_load_dwordx4 v[84:87], v3, s[24:27], s47 offen offset:2048 sc1
    s_add_u32 s47, s46, 12288
    buffer_load_dwordx4 v[88:91], v3, s[24:27], s47 offen offset:0 sc1
    buffer_load_dwordx4 v[92:95], v3, s[24:27], s47 offen offset:2048 sc1
    ds_read_b128 v[48:51], v4 offset:1024
    ds_read_b128 v[52:55], v4 offset:33792
    ds_read_b128 v[56:59], v5 offset:1024
    ds_read_b128 v[60:63], v5 offset:33792
    s_waitcnt vmcnt(7) lgkmcnt(7)
    v_mfma_f32_16x16x32_bf16 v[16:19], v[32:35], v[64:67], v[16:19]
    ds_read_b128 v[32:35], v4 offset:2048
    s_waitcnt lgkmcnt(7)
    v_mfma_f32_16x16x32_bf16 v[20:23], v[36:39], v[64:67], v[20:23]
    ds_read_b128 v[36:39], v4 offset:34816
    s_waitcnt lgkmcnt(7)
    v_mfma_f32_16x16x32_bf16 v[24:27], v[40:43], v[64:67], v[24:27]
    ds_read_b128 v[40:43], v5 offset:2048
    s_waitcnt lgkmcnt(7)
    v_mfma_f32_16x16x32_bf16 v[28:31], v[44:47], v[64:67], v[28:31]
    ds_read_b128 v[44:47], v5 offset:34816
    s_waitcnt vmcnt(6) lgkmcnt(7)
    v_mfma_f32_16x16x32_bf16 v[16:19], v[48:51], v[68:71], v[16:19]
    ds_read_b128 v[48:51], v4 offset:3072
    s_waitcnt lgkmcnt(7)
    v_mfma_f32_16x16x32_bf16 v[20:23], v[52:55], v[68:71], v[20:23]
    ds_read_b128 v[52:55], v4 offset:35840
    s_waitcnt lgkmcnt(7)
    v_mfma_f32_16x16x32_bf16 v[24:27], v[56:59], v[68:71], v[24:27]
    ds_read_b128 v[56:59], v5 offset:3072
    s_waitcnt lgkmcnt(7)
    v_mfma_f32_16x16x32_bf16 v[28:31], v[60:63], v[68:71], v[28:31]
    ds_read_b128 v[60:63], v5 offset:35840
    s_waitcnt vmcnt(5) lgkmcnt(7)
    v_mfma_f32_16x16x32_bf16 v[16:19], v[32:35], v[72:75], v[16:19]
    ds_read_b128 v[32:35], v4 offset:4096
    s_waitcnt lgkmcnt(7)
    v_mfma_f32_16x16x32_bf16 v[20:23], v[36:39], v[72:75], v[20:23]
    ds_read_b128 v[36:39], v4 offset:36864
    s_waitcnt lgkmcnt(7)
    v_mfma_f32_16x16x32_bf16 v[24:27], v[40:43], v[72:75], v[24:27]
    ds_read_b128 v[40:43], v5 offset:4096
    s_waitcnt lgkmcnt(7)
    v_mfma_f32_16x16x32_bf16 v[28:31], v[44:47], v[72:75], v[28:31]
    ds_read_b128 v[44:47], v5 offset:36864
    s_waitcnt vmcnt(4) lgkmcnt(7)
    v_mfma_f32_16x16x32_bf16 v[16:19], v[48:51], v[76:79], v[16:19]
    ds_read_b128 v[48:51], v4 offset:5120
    s_waitcnt lgkmcnt(7)
    v_mfma_f32_16x16x32_bf16 v[20:23], v[52:55], v[76:79], v[20:23]
    ds_read_b128 v[52:55], v4 offset:37888
    s_waitcnt lgkmcnt(7)
    v_mfma_f32_16x16x32_bf16 v[24:27], v[56:59], v[76:79], v[24:27]
    ds_read_b128 v[56:59], v5 offset:5120
    s_waitcnt lgkmcnt(7)
    v_mfma_f32_16x16x32_bf16 v[28:31], v[60:63], v[76:79], v[28:31]
    ds_read_b128 v[60:63], v5 offset:37888
    s_waitcnt vmcnt(3) lgkmcnt(7)
    v_mfma_f32_16x16x32_bf16 v[16:19], v[32:35], v[80:83], v[16:19]
    ds_read_b128 v[32:35], v4 offset:6144
    s_waitcnt lgkmcnt(7)
    v_mfma_f32_16x16x32_bf16 v[20:23], v[36:39], v[80:83], v[20:23]
    ds_read_b128 v[36:39], v4 offset:38912
    s_waitcnt lgkmcnt(7)
    v_mfma_f32_16x16x32_bf16 v[24:27], v[40:43], v[80:83], v[24:27]
    ds_read_b128 v[40:43], v5 offset:6144
    s_waitcnt lgkmcnt(7)
    v_mfma_f32_16x16x32_bf16 v[28:31], v[44:47], v[80:83], v[28:31]
    ds_read_b128 v[44:47], v5 offset:38912
    s_waitcnt vmcnt(2) lgkmcnt(7)
    v_mfma_f32_16x16x32_bf16 v[16:19], v[48:51], v[84:87], v[16:19]
    ds_read_b128 v[48:51], v4 offset:7168
    s_waitcnt lgkmcnt(7)
    v_mfma_f32_16x16x32_bf16 v[20:23], v[52:55], v[84:87], v[20:23]
    ds_read_b128 v[52:55], v4 offset:39936
    s_waitcnt lgkmcnt(7)
    v_mfma_f32_16x16x32_bf16 v[24:27], v[56:59], v[84:87], v[24:27]
    ds_read_b128 v[56:59], v5 offset:7168
    s_waitcnt lgkmcnt(7)
    v_mfma_f32_16x16x32_bf16 v[28:31], v[60:63], v[84:87], v[28:31]
    ds_read_b128 v[60:63], v5 offset:39936
    s_waitcnt vmcnt(1) lgkmcnt(7)
    v_mfma_f32_16x16x32_bf16 v[16:19], v[32:35], v[88:91], v[16:19]
    s_waitcnt lgkmcnt(6)
    v_mfma_f32_16x16x32_bf16 v[20:23], v[36:39], v[88:91], v[20:23]
    s_waitcnt lgkmcnt(5)
    v_mfma_f32_16x16x32_bf16 v[24:27], v[40:43], v[88:91], v[24:27]
    s_waitcnt lgkmcnt(4)
    v_mfma_f32_16x16x32_bf16 v[28:31], v[44:47], v[88:91], v[28:31]
    s_waitcnt vmcnt(0) lgkmcnt(3)
    v_mfma_f32_16x16x32_bf16 v[16:19], v[48:51], v[92:95], v[16:19]
    s_waitcnt lgkmcnt(2)
    v_mfma_f32_16x16x32_bf16 v[20:23], v[52:55], v[92:95], v[20:23]
    s_waitcnt lgkmcnt(1)
    v_mfma_f32_16x16x32_bf16 v[24:27], v[56:59], v[92:95], v[24:27]
    s_waitcnt lgkmcnt(0)
    v_mfma_f32_16x16x32_bf16 v[28:31], v[60:63], v[92:95], v[28:31]
    s_barrier
    v_mov_b32 v100, 66560
    v_mov_b32 v102, 0
    v_mov_b32 v103, 0
    ds_write_b64 v100, v[102:103]
    s_lshl_b32 s60, s28, 11
    s_add_u32 s60, s60, 0
    v_add_u32 v12, s60, v2
    s_xor_b32 s60, s60, 8192
    v_add_u32 v13, s60, v2
    s_cmp_eq_u32 s61, 0
    s_cbranch_scc0 L_ex1_b
    ds_write_b128 v12, v[24:27]
    ds_write_b128 v12, v[28:31] offset:1024
    s_branch L_ex2_b
L_ex1_b:
    ds_write_b128 v12, v[16:19]
    ds_write_b128 v12, v[20:23] offset:1024
    v_mov_b32 v16, v24
    v_mov_b32 v17, v25
    v_mov_b32 v18, v26
    v_mov_b32 v19, v27
    v_mov_b32 v20, v28
    v_mov_b32 v21, v29
    v_mov_b32 v22, v30
    v_mov_b32 v23, v31
L_ex2_b:
    s_waitcnt lgkmcnt(0)
    s_barrier
    ds_read_b128 v[32:35], v13
    ds_read_b128 v[36:39], v13 offset:1024
    v_lshlrev_b32 v40, 16, v96
    v_and_b32 v41, 0xffff0000, v96
    v_lshlrev_b32 v42, 16, v97
    v_and_b32 v43, 0xffff0000, v97
    v_lshlrev_b32 v44, 16, v98
    v_and_b32 v45, 0xffff0000, v98
    v_lshlrev_b32 v46, 16, v99
    v_and_b32 v47, 0xffff0000, v99
    s_lshl_b32 s47, s36, 4
    s_add_u32 s47, s47, s37
    s_lshl_b32 s46, s47, 7
    s_add_u32 s33, s46, 20185088
    s_add_u32 s46, s46, 15925248
    s_lshl_b32 s47, s47, 10
    s_add_u32 s47, s47, 4194304
    v_add_f32 v16, v16, v40
    v_add_f32 v17, v17, v41
    v_add_f32 v18, v18, v42
    v_add_f32 v19, v19, v43
    v_add_f32 v20, v20, v44
    v_add_f32 v21, v21, v45
    v_add_f32 v22, v22, v46
    v_add_f32 v23, v23, v47
    s_waitcnt lgkmcnt(0)
    v_add_f32 v16, v16, v32
    v_add_f32 v17, v17, v33
    v_add_f32 v18, v18, v34
    v_add_f32 v19, v19, v35
    v_add_f32 v20, v20, v36
    v_add_f32 v21, v21, v37
    v_add_f32 v22, v22, v38
    v_add_f32 v23, v23, v39
    v_cvt_pk_bf16_f32 v48, v16, v17
    v_cvt_pk_bf16_f32 v49, v18, v19
    v_cvt_pk_bf16_f32 v50, v20, v21
    v_cvt_pk_bf16_f32 v51, v22, v23
    buffer_store_dwordx4 v[48:51], v2, s[24:27], s47 offen sc1
    v_mov_b32 v54, 0x3f803f80
    v_dot2_f32_bf16 v52, v48, v54, 0
    v_dot2_f32_bf16 v53, v48, v48, 0
    v_dot2_f32_bf16 v52, v49, v54, v52
    v_dot2_f32_bf16 v53, v49, v49, v53
    v_dot2_f32_bf16 v52, v50, v54, v52
    v_dot2_f32_bf16 v53, v50, v50, v53
    v_dot2_f32_bf16 v52, v51, v54, v52
    v_dot2_f32_bf16 v53, v51, v51, v53
    s_nop 1
    v_mov_b32 v12, v52
    s_nop 1
    v_permlane32_swap_b32 v52, v12
    v_add_f32 v52, v52, v12
    v_mov_b32 v13, v53
    s_nop 1
    v_permlane32_swap_b32 v53, v13
    v_add_f32 v53, v53, v13
    v_mov_b32 v12, v52
    s_nop 1
    v_permlane16_swap_b32 v52, v12
    v_add_f32 v52, v52, v12
    v_mov_b32 v13, v53
    s_nop 1
    v_permlane16_swap_b32 v53, v13
    v_add_f32 v53, v53, v13
    v_lshlrev_b32 v12, 3, v14
    s_mov_b64 exec, 0xffff
    buffer_store_dwordx2 v[52:53], v12, s[24:27], s46 offen sc1
    s_mov_b64 exec, -1
    s_and_b32 s31, s29, 1
    s_lshl_b32 s31, s31, 3
    s_add_u32 s30, s30, s31
    s_lshr_b32 s29, s29, 1
    s_mul_i32 s31, s30, 3
    s_min_u32 s31, s31, 40
    s_lshl_b32 s36, s29, 3
    s_add_u32 s36, s36, s28
    s_lshl_b32 s62, s36, 11
    s_add_u32 s62, s62, 20185088
    s_lshl_b32 s47, s36, 11
    s_add_u32 s47, s47, 16252928
    v_mov_b32 v4, v2
    v_add_u32 v5, 65536, v4
    v_add_u32 v6, 131072, v4
    v_lshlrev_b32 v7, 3, v14
    v_lshl_add_u32 v7, v8, 9, v7
    s_waitcnt vmcnt(0)
    v_mov_b32 v12, s58
    v_mov_b32 v13, s59
    v_mov_b32 v15, 0
    s_mov_b64 exec, 1
    s_cmp_lg_u32 s63, 0
    s_cbranch_scc1 L_sequential_preLN__grouped_kv_mqa__mixer_gmlp__prompt_kernel_hs_3
    buffer_store_dwordx2 v[12:13], v15, s[24:27], s33 offen sc1
    s_branch L_sequential_preLN__grouped_kv_mqa__mixer_gmlp__prompt_kernel_hs_4
L_sequential_preLN__grouped_kv_mqa__mixer_gmlp__prompt_kernel_hs_3:
    buffer_store_dwordx2 v[12:13], v15, s[24:27], s33 offen
L_sequential_preLN__grouped_kv_mqa__mixer_gmlp__prompt_kernel_hs_4:
    s_mov_b64 exec, -1
    s_cmp_eq_u32 s30, 15
    s_cbranch_scc0 L_k4_work
    v_mov_b32 v16, 0
    v_mov_b32 v17, 0
    v_lshlrev_b32 v12, 3, v14
    s_add_u32 s47, s47, 1920
    buffer_store_dwordx2 v[16:17], v12, s[24:27], s47 offen sc1
    v_mov_b32 v12, 66560
    v_mov_b32 v13, 1
    s_mov_b64 exec, 1
    ds_add_u32 v12, v13
    s_mov_b64 exec, -1
    s_branch L_z_done
L_k4_work:
    v_mov_b32 v16, 0
    v_mov_b32 v17, 0
    v_mov_b32 v18, 0
    v_mov_b32 v19, 0
    v_mov_b32 v20, 0
    v_mov_b32 v21, 0
    v_mov_b32 v22, 0
    v_mov_b32 v23, 0
    v_mov_b32 v24, 0
    v_mov_b32 v25, 0
    v_mov_b32 v26, 0
    v_mov_b32 v27, 0
    v_mov_b32 v28, 0
    v_mov_b32 v29, 0
    v_mov_b32 v30, 0
    v_mov_b32 v31, 0
    v_mov_b32 v32, 0
    v_mov_b32 v33, 0
    v_mov_b32 v34, 0
    v_mov_b32 v35, 0
    v_mov_b32 v36, 0
    v_mov_b32 v37, 0
    v_mov_b32 v38, 0
    v_mov_b32 v39, 0
    ds_read_b128 v[40:43], v4 offset:16384
    ds_read_b128 v[44:47], v5 offset:16384
    ds_read_b128 v[48:51], v4 offset:24576
    ds_read_b128 v[52:55], v6 offset:20480
    ds_read_b128 v[56:59], v6 offset:0
    ds_read_b128 v[60:63], v5 offset:30720
    s_lshl_b32 s46, s36, 14
    s_add_u32 s46, s46, 4194304
    s_lshl_b32 s45, s36, 11
    s_add_u32 s45, s45, 15925248
    v_lshlrev_b32 v15, 7, v1
    s_mov_b64 exec, 0xffff
    s_mov_b32 s60, 0
L_poll_h:
    buffer_load_dwordx2 v[12:13], v15, s[24:27], s62 offen sc1
    s_add_u32 s60, s60, 1
    s_waitcnt vmcnt(0)
    v_xor_b32 v12, s58, v12
    v_xor_b32 v13, s59, v13
    v_or_b32 v12, v12, v13
    v_cmp_ne_u32 vcc, 0, v12
    s_cmp_gt_u32 s60, 0x40000
    s_cbranch_scc1 L_pollok_h
    s_cbranch_vccz L_pollok_h
    s_sleep 2
    s_branch L_poll_h
L_pollok_h:
    s_mov_b64 exec, -1
    s_add_u32 s44, s46, 0
    buffer_load_dwordx4 v[64:67], v2, s[24:27], s44 offen offset:0 sc1
    buffer_load_dwordx4 v[68:71], v2, s[24:27], s44 offen offset:1024 sc1
    buffer_load_dwordx4 v[72:75], v2, s[24:27], s44 offen offset:2048 sc1
    buffer_load_dwordx4 v[76:79], v2, s[24:27], s44 offen offset:3072 sc1
    s_add_u32 s44, s46, 4096
    buffer_load_dwordx4 v[80:83], v2, s[24:27], s44 offen offset:0 sc1
    buffer_load_dwordx4 v[84:87], v2, s[24:27], s44 offen offset:1024 sc1
    s_waitcnt vmcnt(5) lgkmcnt(5)
    v_mfma_f32_16x16x32_bf16 v[16:19], v[64:67], v[40:43], v[16:19]
    ds_read_b128 v[40:43], v4 offset:17408
    s_waitcnt lgkmcnt(5)
    v_mfma_f32_16x16x32_bf16 v[20:23], v[64:67], v[44:47], v[20:23]
    ds_read_b128 v[44:47], v5 offset:17408
    s_waitcnt lgkmcnt(5)
    v_mfma_f32_16x16x32_bf16 v[24:27], v[64:67], v[48:51], v[24:27]
    ds_read_b128 v[48:51], v4 offset:25600
    buffer_load_dwordx4 v[88:91], v2, s[24:27], s44 offen offset:2048 sc1
    s_waitcnt lgkmcnt(5)
    v_mfma_f32_16x16x32_bf16 v[28:31], v[52:55], v[64:67], v[28:31]
    ds_read_b128 v[52:55], v6 offset:21504
    s_waitcnt lgkmcnt(5)
    v_mfma_f32_16x16x32_bf16 v[32:35], v[56:59], v[64:67], v[32:35]
    ds_read_b128 v[56:59], v6 offset:1024
    s_waitcnt lgkmcnt(5)
    v_mfma_f32_16x16x32_bf16 v[36:39], v[60:63], v[64:67], v[36:39]
    ds_read_b128 v[60:63], v5 offset:31744
    s_waitcnt vmcnt(5) lgkmcnt(5)
    v_mfma_f32_16x16x32_bf16 v[16:19], v[68:71], v[40:43], v[16:19]
    ds_read_b128 v[40:43], v4 offset:18432
    s_waitcnt lgkmcnt(5)
    v_mfma_f32_16x16x32_bf16 v[20:23], v[68:71], v[44:47], v[20:23]
    ds_read_b128 v[44:47], v5 offset:18432
    s_waitcnt lgkmcnt(5)
    v_mfma_f32_16x16x32_bf16 v[24:27], v[68:71], v[48:51], v[24:27]
    ds_read_b128 v[48:51], v4 offset:26624
    buffer_load_dwordx4 v[92:95], v2, s[24:27], s44 offen offset:3072 sc1
    s_waitcnt lgkmcnt(5)
    v_mfma_f32_16x16x32_bf16 v[28:31], v[52:55], v[68:71], v[28:31]
    ds_read_b128 v[52:55], v6 offset:22528
    s_waitcnt lgkmcnt(5)
    v_mfma_f32_16x16x32_bf16 v[32:35], v[56:59], v[68:71], v[32:35]
    ds_read_b128 v[56:59], v6 offset:2048
    s_waitcnt lgkmcnt(5)
    v_mfma_f32_16x16x32_bf16 v[36:39], v[60:63], v[68:71], v[36:39]
    ds_read_b128 v[60:63], v6 offset:10240
    s_waitcnt vmcnt(5) lgkmcnt(5)
    v_mfma_f32_16x16x32_bf16 v[16:19], v[72:75], v[40:43], v[16:19]
    ds_read_b128 v[40:43], v4 offset:19456
    s_waitcnt lgkmcnt(5)
    v_mfma_f32_16x16x32_bf16 v[20:23], v[72:75], v[44:47], v[20:23]
    ds_read_b128 v[44:47], v5 offset:19456
    s_waitcnt lgkmcnt(5)
    v_mfma_f32_16x16x32_bf16 v[24:27], v[72:75], v[48:51], v[24:27]
    ds_read_b128 v[48:51], v4 offset:27648
    s_add_u32 s44, s46, 8192
    buffer_load_dwordx4 v[96:99], v2, s[24:27], s44 offen offset:0 sc1
    s_waitcnt lgkmcnt(5)
    v_mfma_f32_16x16x32_bf16 v[28:31], v[52:55], v[72:75], v[28:31]
    ds_read_b128 v[52:55], v6 offset:23552
    s_waitcnt lgkmcnt(5)
    v_mfma_f32_16x16x32_bf16 v[32:35], v[56:59], v[72:75], v[32:35]
    ds_read_b128 v[56:59], v6 offset:3072
    s_waitcnt lgkmcnt(5)
    v_mfma_f32_16x16x32_bf16 v[36:39], v[60:63], v[72:75], v[36:39]
    ds_read_b128 v[60:63], v6 offset:11264
    s_waitcnt vmcnt(5) lgkmcnt(5)
    v_mfma_f32_16x16x32_bf16 v[16:19], v[76:79], v[40:43], v[16:19]
    ds_read_b128 v[40:43], v4 offset:20480
    s_waitcnt lgkmcnt(5)
    v_mfma_f32_16x16x32_bf16 v[20:23], v[76:79], v[44:47], v[20:23]
    ds_read_b128 v[44:47], v5 offset:20480
    s_waitcnt lgkmcnt(5)
    v_mfma_f32_16x16x32_bf16 v[24:27], v[76:79], v[48:51], v[24:27]
    ds_read_b128 v[48:51], v4 offset:57344
    buffer_load_dwordx4 v[100:103], v2, s[24:27], s44 offen offset:1024 sc1
    s_waitcnt lgkmcnt(5)
    v_mfma_f32_16x16x32_bf16 v[28:31], v[52:55], v[76:79], v[28:31]
    ds_read_b128 v[52:55], v6 offset:24576
    s_waitcnt lgkmcnt(5)
    v_mfma_f32_16x16x32_bf16 v[32:35], v[56:59], v[76:79], v[32:35]
    ds_read_b128 v[56:59], v6 offset:4096
    s_waitcnt lgkmcnt(5)
    v_mfma_f32_16x16x32_bf16 v[36:39], v[60:63], v[76:79], v[36:39]
    ds_read_b128 v[60:63], v6 offset:12288
    s_waitcnt vmcnt(5) lgkmcnt(5)
    v_mfma_f32_16x16x32_bf16 v[16:19], v[80:83], v[40:43], v[16:19]
    ds_read_b128 v[40:43], v4 offset:21504
    s_waitcnt lgkmcnt(5)
    v_mfma_f32_16x16x32_bf16 v[20:23], v[80:83], v[44:47], v[20:23]
    ds_read_b128 v[44:47], v5 offset:21504
    s_waitcnt lgkmcnt(5)
    v_mfma_f32_16x16x32_bf16 v[24:27], v[80:83], v[48:51], v[24:27]
    ds_read_b128 v[48:51], v4 offset:58368
    buffer_load_dwordx4 v[104:107], v2, s[24:27], s44 offen offset:2048 sc1
    s_waitcnt lgkmcnt(5)
    v_mfma_f32_16x16x32_bf16 v[28:31], v[52:55], v[80:83], v[28:31]
    ds_read_b128 v[52:55], v6 offset:25600
    s_waitcnt lgkmcnt(5)
    v_mfma_f32_16x16x32_bf16 v[32:35], v[56:59], v[80:83], v[32:35]
    ds_read_b128 v[56:59], v4 offset:61440
    s_waitcnt lgkmcnt(5)
    v_mfma_f32_16x16x32_bf16 v[36:39], v[60:63], v[80:83], v[36:39]
    ds_read_b128 v[60:63], v6 offset:13312
    s_waitcnt vmcnt(5) lgkmcnt(5)
    v_mfma_f32_16x16x32_bf16 v[16:19], v[84:87], v[40:43], v[16:19]
    ds_read_b128 v[40:43], v4 offset:22528
    s_waitcnt lgkmcnt(5)
    v_mfma_f32_16x16x32_bf16 v[20:23], v[84:87], v[44:47], v[20:23]
    ds_read_b128 v[44:47], v5 offset:22528
    s_waitcnt lgkmcnt(5)
    v_mfma_f32_16x16x32_bf16 v[24:27], v[84:87], v[48:51], v[24:27]
    ds_read_b128 v[48:51], v4 offset:59392
    buffer_load_dwordx4 v[108:111], v2, s[24:27], s44 offen offset:3072 sc1
    s_waitcnt lgkmcnt(5)
    v_mfma_f32_16x16x32_bf16 v[28:31], v[52:55], v[84:87], v[28:31]
    ds_read_b128 v[52:55], v6 offset:26624
    s_waitcnt lgkmcnt(5)
    v_mfma_f32_16x16x32_bf16 v[32:35], v[56:59], v[84:87], v[32:35]
    ds_read_b128 v[56:59], v4 offset:62464
    s_waitcnt lgkmcnt(5)
    v_mfma_f32_16x16x32_bf16 v[36:39], v[60:63], v[84:87], v[36:39]
    ds_read_b128 v[60:63], v6 offset:14336
    s_waitcnt vmcnt(5) lgkmcnt(5)
    v_mfma_f32_16x16x32_bf16 v[16:19], v[88:91], v[40:43], v[16:19]
    ds_read_b128 v[40:43], v4 offset:23552
    s_waitcnt lgkmcnt(5)
    v_mfma_f32_16x16x32_bf16 v[20:23], v[88:91], v[44:47], v[20:23]
    ds_read_b128 v[44:47], v5 offset:23552
    s_waitcnt lgkmcnt(5)
    v_mfma_f32_16x16x32_bf16 v[24:27], v[88:91], v[48:51], v[24:27]
    ds_read_b128 v[48:51], v4 offset:60416
    s_add_u32 s44, s46, 12288
    buffer_load_dwordx4 v[112:115], v2, s[24:27], s44 offen offset:0 sc1
    s_waitcnt lgkmcnt(5)
    v_mfma_f32_16x16x32_bf16 v[28:31], v[52:55], v[88:91], v[28:31]
    ds_read_b128 v[52:55], v6 offset:27648
    s_waitcnt lgkmcnt(5)
    v_mfma_f32_16x16x32_bf16 v[32:35], v[56:59], v[88:91], v[32:35]
    ds_read_b128 v[56:59], v4 offset:63488
    s_waitcnt lgkmcnt(5)
    v_mfma_f32_16x16x32_bf16 v[36:39], v[60:63], v[88:91], v[36:39]
    ds_read_b128 v[60:63], v5 offset:61440
    s_waitcnt vmcnt(5) lgkmcnt(5)
    v_mfma_f32_16x16x32_bf16 v[16:19], v[92:95], v[40:43], v[16:19]
    ds_read_b128 v[40:43], v4 offset:49152
    s_waitcnt lgkmcnt(5)
    v_mfma_f32_16x16x32_bf16 v[20:23], v[92:95], v[44:47], v[20:23]
    ds_read_b128 v[44:47], v5 offset:49152
    s_waitcnt lgkmcnt(5)
    v_mfma_f32_16x16x32_bf16 v[24:27], v[92:95], v[48:51], v[24:27]
    ds_read_b128 v[48:51], v5 offset:24576
    buffer_load_dwordx4 v[116:119], v2, s[24:27], s44 offen offset:1024 sc1
    buffer_load_dwordx2 v[8:9], v7, s[24:27], s45 offen offset:0 sc1
    buffer_load_dwordx2 v[10:11], v7, s[24:27], s45 offen offset:128 sc1
    buffer_load_dwordx2 v[12:13], v7, s[24:27], s45 offen offset:256 sc1
    buffer_load_dwordx2 v[14:15], v7, s[24:27], s45 offen offset:384 sc1
    s_waitcnt lgkmcnt(5)
    v_mfma_f32_16x16x32_bf16 v[28:31], v[52:55], v[92:95], v[28:31]
    ds_read_b128 v[52:55], v6 offset:28672
    s_waitcnt lgkmcnt(5)
    v_mfma_f32_16x16x32_bf16 v[32:35], v[56:59], v[92:95], v[32:35]
    ds_read_b128 v[56:59], v4 offset:64512
    s_waitcnt lgkmcnt(5)
    v_mfma_f32_16x16x32_bf16 v[36:39], v[60:63], v[92:95], v[36:39]
    ds_read_b128 v[60:63], v5 offset:62464
    s_waitcnt vmcnt(9) lgkmcnt(5)
    v_mfma_f32_16x16x32_bf16 v[16:19], v[96:99], v[40:43], v[16:19]
    ds_read_b128 v[40:43], v4 offset:50176
    s_waitcnt lgkmcnt(5)
    v_mfma_f32_16x16x32_bf16 v[20:23], v[96:99], v[44:47], v[20:23]
    ds_read_b128 v[44:47], v5 offset:50176
    s_waitcnt lgkmcnt(5)
    v_mfma_f32_16x16x32_bf16 v[24:27], v[96:99], v[48:51], v[24:27]
    ds_read_b128 v[48:51], v5 offset:25600
    buffer_load_dwordx4 v[120:123], v2, s[24:27], s44 offen offset:2048 sc1
    s_waitcnt lgkmcnt(5)
    v_mfma_f32_16x16x32_bf16 v[28:31], v[52:55], v[96:99], v[28:31]
    ds_read_b128 v[52:55], v6 offset:29696
    s_waitcnt lgkmcnt(5)
    v_mfma_f32_16x16x32_bf16 v[32:35], v[56:59], v[96:99], v[32:35]
    ds_read_b128 v[56:59], v6 offset:5120
    s_waitcnt lgkmcnt(5)
    v_mfma_f32_16x16x32_bf16 v[36:39], v[60:63], v[96:99], v[36:39]
    ds_read_b128 v[60:63], v5 offset:63488
    v_and_b32 v3, 15, v1
    v_lshlrev_b32 v3, 2, v3
    s_lshl_b32 s38, s31, 6
    s_add_u32 s38, s38, 16187392
    s_add_u32 s39, s38, 2752
    buffer_load_dword v64, v3, s[24:27], s39 offen offset:0 sc1
    buffer_load_dword v65, v3, s[24:27], s39 offen offset:64 sc1
    buffer_load_dword v66, v3, s[24:27], s39 offen offset:128 sc1
    s_add_u32 s39, s39, 8192
    buffer_load_dword v67, v3, s[24:27], s39 offen offset:0 sc1
    buffer_load_dword v68, v3, s[24:27], s39 offen offset:64 sc1
    buffer_load_dword v69, v3, s[24:27], s39 offen offset:128 sc1
    s_add_u32 s39, s39, 8192
    v_lshrrev_b32 v3, 4, v1
    v_lshlrev_b32 v3, 4, v3
    buffer_load_dwordx4 v[72:75], v3, s[24:27], s38 offen offset:0 sc1
    buffer_load_dwordx4 v[76:79], v3, s[24:27], s38 offen offset:64 sc1
    buffer_load_dwordx4 v[80:83], v3, s[24:27], s38 offen offset:128 sc1
    s_add_u32 s38, s38, 8192
    buffer_load_dwordx4 v[84:87], v3, s[24:27], s38 offen offset:0 sc1
    buffer_load_dwordx4 v[88:91], v3, s[24:27], s38 offen offset:64 sc1
    buffer_load_dwordx4 v[92:95], v3, s[24:27], s38 offen offset:128 sc1
    s_add_u32 s38, s38, 8192
    s_waitcnt vmcnt(21) lgkmcnt(5)
    v_mfma_f32_16x16x32_bf16 v[16:19], v[100:103], v[40:43], v[16:19]
    ds_read_b128 v[40:43], v4 offset:51200
    s_waitcnt lgkmcnt(5)
    v_mfma_f32_16x16x32_bf16 v[20:23], v[100:103], v[44:47], v[20:23]
    ds_read_b128 v[44:47], v5 offset:51200
    s_waitcnt lgkmcnt(5)
    v_mfma_f32_16x16x32_bf16 v[24:27], v[100:103], v[48:51], v[24:27]
    ds_read_b128 v[48:51], v5 offset:26624
    buffer_load_dwordx4 v[124:127], v2, s[24:27], s44 offen offset:3072 sc1
    s_waitcnt lgkmcnt(5)
    v_mfma_f32_16x16x32_bf16 v[28:31], v[52:55], v[100:103], v[28:31]
    ds_read_b128 v[52:55], v6 offset:30720
    s_waitcnt lgkmcnt(5)
    v_mfma_f32_16x16x32_bf16 v[32:35], v[56:59], v[100:103], v[32:35]
    ds_read_b128 v[56:59], v6 offset:6144
    s_waitcnt lgkmcnt(5)
    v_mfma_f32_16x16x32_bf16 v[36:39], v[60:63], v[100:103], v[36:39]
    ds_read_b128 v[60:63], v5 offset:64512
    s_waitcnt vmcnt(21) lgkmcnt(5)
    v_mfma_f32_16x16x32_bf16 v[16:19], v[104:107], v[40:43], v[16:19]
    ds_read_b128 v[40:43], v4 offset:52224
    s_waitcnt lgkmcnt(5)
    v_mfma_f32_16x16x32_bf16 v[20:23], v[104:107], v[44:47], v[20:23]
    ds_read_b128 v[44:47], v5 offset:52224
    s_waitcnt lgkmcnt(5)
    v_mfma_f32_16x16x32_bf16 v[24:27], v[104:107], v[48:51], v[24:27]
    ds_read_b128 v[48:51], v5 offset:27648
    s_waitcnt lgkmcnt(5)
    v_mfma_f32_16x16x32_bf16 v[28:31], v[52:55], v[104:107], v[28:31]
    ds_read_b128 v[52:55], v6 offset:31744
    s_waitcnt lgkmcnt(5)
    v_mfma_f32_16x16x32_bf16 v[32:35], v[56:59], v[104:107], v[32:35]
    ds_read_b128 v[56:59], v6 offset:7168
    s_waitcnt lgkmcnt(5)
    v_mfma_f32_16x16x32_bf16 v[36:39], v[60:63], v[104:107], v[36:39]
    ds_read_b128 v[60:63], v6 offset:15360
    s_waitcnt vmcnt(20) lgkmcnt(5)
    v_mfma_f32_16x16x32_bf16 v[16:19], v[108:111], v[40:43], v[16:19]
    ds_read_b128 v[40:43], v4 offset:53248
    s_waitcnt lgkmcnt(5)
    v_mfma_f32_16x16x32_bf16 v[20:23], v[108:111], v[44:47], v[20:23]
    ds_read_b128 v[44:47], v5 offset:53248
    s_waitcnt lgkmcnt(5)
    v_mfma_f32_16x16x32_bf16 v[24:27], v[108:111], v[48:51], v[24:27]
    ds_read_b128 v[48:51], v5 offset:57344
    s_waitcnt lgkmcnt(5)
    v_mfma_f32_16x16x32_bf16 v[28:31], v[52:55], v[108:111], v[28:31]
    ds_read_b128 v[52:55], v4 offset:28672
    s_waitcnt lgkmcnt(5)
    v_mfma_f32_16x16x32_bf16 v[32:35], v[56:59], v[108:111], v[32:35]
    ds_read_b128 v[56:59], v6 offset:8192
    s_waitcnt lgkmcnt(5)
    v_mfma_f32_16x16x32_bf16 v[36:39], v[60:63], v[108:111], v[36:39]
    ds_read_b128 v[60:63], v6 offset:16384
    s_waitcnt vmcnt(19) lgkmcnt(5)
    v_mfma_f32_16x16x32_bf16 v[16:19], v[112:115], v[40:43], v[16:19]
    ds_read_b128 v[40:43], v4 offset:54272
    s_waitcnt lgkmcnt(5)
    v_mfma_f32_16x16x32_bf16 v[20:23], v[112:115], v[44:47], v[20:23]
    ds_read_b128 v[44:47], v5 offset:54272
    s_waitcnt lgkmcnt(5)
    v_mfma_f32_16x16x32_bf16 v[24:27], v[112:115], v[48:51], v[24:27]
    ds_read_b128 v[48:51], v5 offset:58368
    s_waitcnt lgkmcnt(5)
    v_mfma_f32_16x16x32_bf16 v[28:31], v[52:55], v[112:115], v[28:31]
    ds_read_b128 v[52:55], v4 offset:29696
    s_waitcnt lgkmcnt(5)
    v_mfma_f32_16x16x32_bf16 v[32:35], v[56:59], v[112:115], v[32:35]
    ds_read_b128 v[56:59], v6 offset:9216
    s_waitcnt lgkmcnt(5)
    v_mfma_f32_16x16x32_bf16 v[36:39], v[60:63], v[112:115], v[36:39]
    ds_read_b128 v[60:63], v6 offset:17408
    s_waitcnt vmcnt(14)
    v_add_f32 v8, v8, v10
    v_add_f32 v9, v9, v11
    v_add_f32 v12, v12, v14
    v_add_f32 v13, v13, v15
    v_add_f32 v8, v8, v12
    v_add_f32 v9, v9, v13
    v_mov_b32 v12, v8
    s_nop 1
    v_permlane32_swap_b32 v8, v12
    v_add_f32 v8, v8, v12
    v_mov_b32 v13, v9
    s_nop 1
    v_permlane32_swap_b32 v9, v13
    v_add_f32 v9, v9, v13
    s_waitcnt vmcnt(18) lgkmcnt(5)
    v_mfma_f32_16x16x32_bf16 v[16:19], v[116:119], v[40:43], v[16:19]
    ds_read_b128 v[40:43], v4 offset:55296
    s_waitcnt lgkmcnt(5)
    v_mfma_f32_16x16x32_bf16 v[20:23], v[116:119], v[44:47], v[20:23]
    ds_read_b128 v[44:47], v5 offset:55296
    s_waitcnt lgkmcnt(5)
    v_mfma_f32_16x16x32_bf16 v[24:27], v[116:119], v[48:51], v[24:27]
    ds_read_b128 v[48:51], v5 offset:59392
    s_waitcnt lgkmcnt(5)
    v_mfma_f32_16x16x32_bf16 v[28:31], v[52:55], v[116:119], v[28:31]
    ds_read_b128 v[52:55], v4 offset:30720
    s_waitcnt lgkmcnt(5)
    v_mfma_f32_16x16x32_bf16 v[32:35], v[56:59], v[116:119], v[32:35]
    ds_read_b128 v[56:59], v5 offset:28672
    s_waitcnt lgkmcnt(5)
    v_mfma_f32_16x16x32_bf16 v[36:39], v[60:63], v[116:119], v[36:39]
    ds_read_b128 v[60:63], v6 offset:18432
    v_mov_b32 v12, v8
    s_nop 1
    v_permlane16_swap_b32 v8, v12
    v_add_f32 v8, v8, v12
    v_mov_b32 v13, v9
    s_nop 1
    v_permlane16_swap_b32 v9, v13
    v_add_f32 v9, v9, v13
    v_mul_f32 v8, 0x3b000000, v8
    v_mul_f32 v9, 0x3b000000, v9
    v_fma_f32 v12, -v8, v8, v9
    v_max_f32 v12, 0, v12
    v_add_f32 v12, 0x3727c5ac, v12
    v_rsq_f32 v9, v12
    s_waitcnt vmcnt(13) lgkmcnt(5)
    v_mfma_f32_16x16x32_bf16 v[16:19], v[120:123], v[40:43], v[16:19]
    ds_read_b128 v[40:43], v4 offset:56320
    s_waitcnt lgkmcnt(5)
    v_mfma_f32_16x16x32_bf16 v[20:23], v[120:123], v[44:47], v[20:23]
    ds_read_b128 v[44:47], v5 offset:56320
    s_waitcnt lgkmcnt(5)
    v_mfma_f32_16x16x32_bf16 v[24:27], v[120:123], v[48:51], v[24:27]
    ds_read_b128 v[48:51], v5 offset:60416
    s_waitcnt lgkmcnt(5)
    v_mfma_f32_16x16x32_bf16 v[28:31], v[52:55], v[120:123], v[28:31]
    ds_read_b128 v[52:55], v4 offset:31744
    s_waitcnt lgkmcnt(5)
    v_mfma_f32_16x16x32_bf16 v[32:35], v[56:59], v[120:123], v[32:35]
    ds_read_b128 v[56:59], v5 offset:29696
    s_waitcnt lgkmcnt(5)
    v_mfma_f32_16x16x32_bf16 v[36:39], v[60:63], v[120:123], v[36:39]
    ds_read_b128 v[60:63], v6 offset:19456
    s_waitcnt vmcnt(0) lgkmcnt(5)
    v_mfma_f32_16x16x32_bf16 v[16:19], v[124:127], v[40:43], v[16:19]
    s_waitcnt lgkmcnt(4)
    v_mfma_f32_16x16x32_bf16 v[20:23], v[124:127], v[44:47], v[20:23]
    s_waitcnt lgkmcnt(3)
    v_mfma_f32_16x16x32_bf16 v[24:27], v[124:127], v[48:51], v[24:27]
    s_waitcnt lgkmcnt(2)
    v_mfma_f32_16x16x32_bf16 v[28:31], v[52:55], v[124:127], v[28:31]
    s_waitcnt lgkmcnt(1)
    v_mfma_f32_16x16x32_bf16 v[32:35], v[56:59], v[124:127], v[32:35]
    s_waitcnt lgkmcnt(0)
    v_mfma_f32_16x16x32_bf16 v[36:39], v[60:63], v[124:127], v[36:39]
    v_add_u32 v12, 0, v3
    ds_bpermute_b32 v96, v12, v8
    ds_bpermute_b32 v100, v12, v9
    v_add_u32 v12, 4, v3
    ds_bpermute_b32 v97, v12, v8
    ds_bpermute_b32 v101, v12, v9
    v_add_u32 v12, 8, v3
    ds_bpermute_b32 v98, v12, v8
    ds_bpermute_b32 v102, v12, v9
    v_add_u32 v12, 12, v3
    ds_bpermute_b32 v99, v12, v8
    ds_bpermute_b32 v103, v12, v9
    s_setprio 0
    v_mov_b32 v12, 66560
    v_mov_b32 v13, 1
    s_mov_b64 exec, 1
    ds_add_u32 v12, v13
    s_mov_b64 exec, -1
    v_mov_b32 v15, 0xbdd2d3e8
    v_and_b32 v14, 15, v1
    s_waitcnt vmcnt(0)
    v_add_f32 v64, v64, v67
    v_add_f32 v65, v65, v68
    v_add_f32 v66, v66, v69
    s_waitcnt lgkmcnt(0)
    v_fma_f32 v16, -v96, v64, v16
    v_fma_f32 v17, -v97, v64, v17
    v_fma_f32 v18, -v98, v64, v18
    v_fma_f32 v19, -v99, v64, v19
    v_fma_f32 v20, -v96, v65, v20
    v_fma_f32 v21, -v97, v65, v21
    v_fma_f32 v22, -v98, v65, v22
    v_fma_f32 v23, -v99, v65, v23
    v_fma_f32 v24, -v96, v66, v24
    v_fma_f32 v25, -v97, v66, v25
    v_fma_f32 v26, -v98, v66, v26
    v_fma_f32 v27, -v99, v66, v27
    v_mul_f32 v16, v100, v16
    v_mul_f32 v17, v101, v17
    v_mul_f32 v18, v102, v18
    v_mul_f32 v19, v103, v19
    v_mul_f32 v20, v100, v20
    v_mul_f32 v21, v101, v21
    v_mul_f32 v22, v102, v22
    v_mul_f32 v23, v103, v23
    v_mul_f32 v24, v100, v24
    v_mul_f32 v25, v101, v25
    v_mul_f32 v26, v102, v26
    v_mul_f32 v27, v103, v27
    v_mul_f32 v40, v16, v16
    v_mul_f32 v41, v17, v17
    v_mul_f32 v42, v18, v18
    v_mul_f32 v43, v19, v19
    v_mul_f32 v44, v20, v20
    v_mul_f32 v45, v21, v21
    v_mul_f32 v46, v22, v22
    v_mul_f32 v47, v23, v23
    v_mul_f32 v48, v24, v24
    v_mul_f32 v49, v25, v25
    v_mul_f32 v50, v26, v26
    v_mul_f32 v51, v27, v27
    v_fmaak_f32 v40, v15, v40, 0xc0135761
    v_fmaak_f32 v41, v15, v41, 0xc0135761
    v_fmaak_f32 v42, v15, v42, 0xc0135761
    v_fmaak_f32 v43, v15, v43, 0xc0135761
    v_fmaak_f32 v44, v15, v44, 0xc0135761
    v_fmaak_f32 v45, v15, v45, 0xc0135761
    v_fmaak_f32 v46, v15, v46, 0xc0135761
    v_fmaak_f32 v47, v15, v47, 0xc0135761
    v_fmaak_f32 v48, v15, v48, 0xc0135761
    v_fmaak_f32 v49, v15, v49, 0xc0135761
    v_fmaak_f32 v50, v15, v50, 0xc0135761
    v_fmaak_f32 v51, v15, v51, 0xc0135761
    v_mul_f32 v40, v40, v16
    v_mul_f32 v41, v41, v17
    v_mul_f32 v42, v42, v18
    v_mul_f32 v43, v43, v19
    v_mul_f32 v44, v44, v20
    v_mul_f32 v45, v45, v21
    v_mul_f32 v46, v46, v22
    v_mul_f32 v47, v47, v23
    v_mul_f32 v48, v48, v24
    v_mul_f32 v49, v49, v25
    v_mul_f32 v50, v50, v26
    v_mul_f32 v51, v51, v27
    v_exp_f32 v40, v40
    v_exp_f32 v41, v41
    v_exp_f32 v42, v42
    v_exp_f32 v43, v43
    v_exp_f32 v44, v44
    v_exp_f32 v45, v45
    v_exp_f32 v46, v46
    v_exp_f32 v47, v47
    v_exp_f32 v48, v48
    v_exp_f32 v49, v49
    v_exp_f32 v50, v50
    v_exp_f32 v51, v51
    v_add_f32 v40, 1.0, v40
    v_add_f32 v41, 1.0, v41
    v_add_f32 v42, 1.0, v42
    v_add_f32 v43, 1.0, v43
    v_add_f32 v44, 1.0, v44
    v_add_f32 v45, 1.0, v45
    v_add_f32 v46, 1.0, v46
    v_add_f32 v47, 1.0, v47
    v_add_f32 v48, 1.0, v48
    v_add_f32 v49, 1.0, v49
    v_add_f32 v50, 1.0, v50
    v_add_f32 v51, 1.0, v51
    v_rcp_f32 v40, v40
    v_rcp_f32 v41, v41
    v_rcp_f32 v42, v42
    v_rcp_f32 v43, v43
    v_rcp_f32 v44, v44
    v_rcp_f32 v45, v45
    v_rcp_f32 v46, v46
    v_rcp_f32 v47, v47
    v_rcp_f32 v48, v48
    v_rcp_f32 v49, v49
    v_rcp_f32 v50, v50
    v_rcp_f32 v51, v51
    v_mul_f32 v16, v16, v40
    v_mul_f32 v17, v17, v41
    v_mul_f32 v18, v18, v42
    v_mul_f32 v19, v19, v43
    v_mul_f32 v20, v20, v44
    v_mul_f32 v21, v21, v45
    v_mul_f32 v22, v22, v46
    v_mul_f32 v23, v23, v47
    v_mul_f32 v24, v24, v48
    v_mul_f32 v25, v25, v49
    v_mul_f32 v26, v26, v50
    v_mul_f32 v27, v27, v51
    v_mov_b32 v52, v24
    v_mul_f32 v53, v24, v24
    v_mov_b32 v54, v25
    v_mul_f32 v55, v25, v25
    v_mov_b32 v56, v26
    v_mul_f32 v57, v26, v26
    v_mov_b32 v58, v27
    v_mul_f32 v59, v27, v27
    s_cmp_eq_u32 s30, 14
    s_cbranch_scc1 L_k4_red
    v_add_f32 v52, v52, v16
    v_fmac_f32 v53, v16, v16
    v_add_f32 v54, v54, v17
    v_fmac_f32 v55, v17, v17
    v_add_f32 v56, v56, v18
    v_fmac_f32 v57, v18, v18
    v_add_f32 v58, v58, v19
    v_fmac_f32 v59, v19, v19
    v_add_f32 v52, v52, v20
    v_fmac_f32 v53, v20, v20
    v_add_f32 v54, v54, v21
    v_fmac_f32 v55, v21, v21
    v_add_f32 v56, v56, v22
    v_fmac_f32 v57, v22, v22
    v_add_f32 v58, v58, v23
    v_fmac_f32 v59, v23, v23
    s_nop 0
L_k4_red:
    v_add_f32_dpp v52, v52, v52 row_ror:8 row_mask:0xf bank_mask:0x3
    v_add_f32_dpp v53, v53, v53 row_ror:8 row_mask:0xf bank_mask:0x3
    v_add_f32_dpp v54, v54, v54 row_ror:8 row_mask:0xf bank_mask:0x3
    v_add_f32_dpp v55, v55, v55 row_ror:8 row_mask:0xf bank_mask:0x3
    v_add_f32_dpp v52, v56, v56 row_ror:8 row_mask:0xf bank_mask:0xc
    v_add_f32_dpp v53, v57, v57 row_ror:8 row_mask:0xf bank_mask:0xc
    v_add_f32_dpp v54, v58, v58 row_ror:8 row_mask:0xf bank_mask:0xc
    v_add_f32_dpp v55, v59, v59 row_ror:8 row_mask:0xf bank_mask:0xc
    v_add_f32_dpp v52, v52, v52 row_half_mirror row_mask:0xf bank_mask:0xf
    v_add_f32_dpp v53, v53, v53 row_half_mirror row_mask:0xf bank_mask:0xf
    v_add_f32_dpp v54, v54, v54 row_half_mirror row_mask:0xf bank_mask:0xf
    v_add_f32_dpp v55, v55, v55 row_half_mirror row_mask:0xf bank_mask:0xf
    v_add_f32_dpp v52, v52, v52 quad_perm:[1,0,3,2] row_mask:0xf bank_mask:0xf
    v_add_f32_dpp v53, v53, v53 quad_perm:[1,0,3,2] row_mask:0xf bank_mask:0xf
    v_add_f32_dpp v54, v54, v54 quad_perm:[1,0,3,2] row_mask:0xf bank_mask:0xf
    v_add_f32_dpp v55, v55, v55 quad_perm:[1,0,3,2] row_mask:0xf bank_mask:0xf
    v_add_f32_dpp v52, v52, v52 quad_perm:[2,3,0,1] row_mask:0xf bank_mask:0xf
    v_add_f32_dpp v53, v53, v53 quad_perm:[2,3,0,1] row_mask:0xf bank_mask:0xf
    v_add_f32_dpp v54, v54, v54 quad_perm:[2,3,0,1] row_mask:0xf bank_mask:0xf
    v_add_f32_dpp v55, v55, v55 quad_perm:[2,3,0,1] row_mask:0xf bank_mask:0xf
    s_mov_b32 s49, -2
    s_lshl_b32 s48, s30, 7
    s_add_u32 s48, s48, s47
    v_lshlrev_b32 v12, 1, v1
    v_min_u32 v52, s49, v52
    v_min_u32 v53, s49, v53
    v_min_u32 v54, s49, v54
    v_min_u32 v55, s49, v55
    s_mov_b32 s50, 0x01010101
    s_mov_b32 s51, 0x01010101
    s_mov_b64 exec, s[50:51]
    s_cmp_lg_u32 s63, 0
    s_cbranch_scc1 L_sequential_preLN__grouped_kv_mqa__mixer_gmlp__prompt_kernel_hs_5
    buffer_store_dwordx4 v[52:55], v12, s[24:27], s48 offen sc1
    s_branch L_sequential_preLN__grouped_kv_mqa__mixer_gmlp__prompt_kernel_hs_6
L_sequential_preLN__grouped_kv_mqa__mixer_gmlp__prompt_kernel_hs_5:
    buffer_store_dwordx4 v[52:55], v12, s[24:27], s48 offen
L_sequential_preLN__grouped_kv_mqa__mixer_gmlp__prompt_kernel_hs_6:
    s_mov_b64 exec, -1
    v_mul_f32 v10, 0xc0135761, v9
    v_mul_f32 v11, v9, v9
    v_mul_f32 v11, v11, v9
    v_mul_f32 v11, 0xbdd2d3e8, v11
    v_rcp_f32 v13, v9
    v_add_f32 v72, v72, v84
    v_add_f32 v73, v73, v85
    v_add_f32 v74, v74, v86
    v_add_f32 v75, v75, v87
    v_add_f32 v76, v76, v88
    v_add_f32 v77, v77, v89
    v_add_f32 v78, v78, v90
    v_add_f32 v79, v79, v91
    v_add_f32 v80, v80, v92
    v_add_f32 v81, v81, v93
    v_add_f32 v82, v82, v94
    v_add_f32 v83, v83, v95
    v_fma_f32 v28, -v8, v72, v28
    v_fma_f32 v29, -v8, v73, v29
    v_fma_f32 v30, -v8, v74, v30
    v_fma_f32 v31, -v8, v75, v31
    v_fma_f32 v32, -v8, v76, v32
    v_fma_f32 v33, -v8, v77, v33
    v_fma_f32 v34, -v8, v78, v34
    v_fma_f32 v35, -v8, v79, v35
    v_fma_f32 v36, -v8, v80, v36
    v_fma_f32 v37, -v8, v81, v37
    v_fma_f32 v38, -v8, v82, v38
    v_fma_f32 v39, -v8, v83, v39
    v_mul_f32 v40, v28, v28
    v_mul_f32 v41, v29, v29
    v_mul_f32 v42, v30, v30
    v_mul_f32 v43, v31, v31
    v_mul_f32 v44, v32, v32
    v_mul_f32 v45, v33, v33
    v_mul_f32 v46, v34, v34
    v_mul_f32 v47, v35, v35
    v_mul_f32 v48, v36, v36
    v_mul_f32 v49, v37, v37
    v_mul_f32 v50, v38, v38
    v_mul_f32 v51, v39, v39
    v_fma_f32 v40, v40, v11, v10
    v_fma_f32 v41, v41, v11, v10
    v_fma_f32 v42, v42, v11, v10
    v_fma_f32 v43, v43, v11, v10
    v_fma_f32 v44, v44, v11, v10
    v_fma_f32 v45, v45, v11, v10
    v_fma_f32 v46, v46, v11, v10
    v_fma_f32 v47, v47, v11, v10
    v_fma_f32 v48, v48, v11, v10
    v_fma_f32 v49, v49, v11, v10
    v_fma_f32 v50, v50, v11, v10
    v_fma_f32 v51, v51, v11, v10
    v_mul_f32 v40, v40, v28
    v_mul_f32 v41, v41, v29
    v_mul_f32 v42, v42, v30
    v_mul_f32 v43, v43, v31
    v_mul_f32 v44, v44, v32
    v_mul_f32 v45, v45, v33
    v_mul_f32 v46, v46, v34
    v_mul_f32 v47, v47, v35
    v_mul_f32 v48, v48, v36
    v_mul_f32 v49, v49, v37
    v_mul_f32 v50, v50, v38
    v_mul_f32 v51, v51, v39
    v_exp_f32 v40, v40
    v_exp_f32 v41, v41
    v_exp_f32 v42, v42
    v_exp_f32 v43, v43
    v_exp_f32 v44, v44
    v_exp_f32 v45, v45
    v_exp_f32 v46, v46
    v_exp_f32 v47, v47
    v_exp_f32 v48, v48
    v_exp_f32 v49, v49
    v_exp_f32 v50, v50
    v_exp_f32 v51, v51
    v_fma_f32 v40, v40, v13, v13
    v_fma_f32 v41, v41, v13, v13
    v_fma_f32 v42, v42, v13, v13
    v_fma_f32 v43, v43, v13, v13
    v_fma_f32 v44, v44, v13, v13
    v_fma_f32 v45, v45, v13, v13
    v_fma_f32 v46, v46, v13, v13
    v_fma_f32 v47, v47, v13, v13
    v_fma_f32 v48, v48, v13, v13
    v_fma_f32 v49, v49, v13, v13
    v_fma_f32 v50, v50, v13, v13
    v_fma_f32 v51, v51, v13, v13
    v_rcp_f32 v40, v40
    v_rcp_f32 v41, v41
    v_rcp_f32 v42, v42
    v_rcp_f32 v43, v43
    v_rcp_f32 v44, v44
    v_rcp_f32 v45, v45
    v_rcp_f32 v46, v46
    v_rcp_f32 v47, v47
    v_rcp_f32 v48, v48
    v_rcp_f32 v49, v49
    v_rcp_f32 v50, v50
    v_rcp_f32 v51, v51
    v_mul_f32 v28, v28, v40
    v_mul_f32 v29, v29, v41
    v_mul_f32 v30, v30, v42
    v_mul_f32 v31, v31, v43
    v_mul_f32 v32, v32, v44
    v_mul_f32 v33, v33, v45
    v_mul_f32 v34, v34, v46
    v_mul_f32 v35, v35, v47
    v_mul_f32 v36, v36, v48
    v_mul_f32 v37, v37, v49
    v_mul_f32 v38, v38, v50
    v_mul_f32 v39, v39, v51
    v_lshrrev_b32 v10, 4, v1
    v_and_b32 v11, 1, v10
    v_lshrrev_b32 v10, 1, v10
    v_lshlrev_b32 v12, 9, v11
    v_lshl_add_u32 v12, v14, 4, v12
    v_lshl_add_u32 v12, v10, 3, v12
    v_lshlrev_b32 v6, 9, v10
    v_lshl_add_u32 v6, v14, 4, v6
    v_lshl_add_u32 v6, v11, 3, v6
    s_lshr_b32 s44, s36, 1
    s_mul_i32 s44, s44, 44
    s_add_u32 s44, s44, s31
    s_lshl_b32 s44, s44, 10
    s_and_b32 s45, s36, 1
    s_lshl_b32 s45, s45, 8
    s_add_u32 s44, s44, s45
    s_add_u32 s44, s44, 6291456
    s_mov_b32 s54, 0
    v_lshlrev_b32 v4, 9, v11
    v_lshl_add_u32 v4, v14, 4, v4
    v_lshl_add_u32 v4, v10, 10, v4
    s_bitcmp1_b32 s31, 0
    s_cselect_b32 s45, 130816, 64
    s_cselect_b32 s46, 0, 2
    s_lshl_b32 s45, s45, s46
    v_mul_lo_u32 v5, v11, s45
    v_lshl_add_u32 v5, v10, 9, v5
    v_lshl_add_u32 v5, v14, 4, v5
    buffer_load_dwordx2 v[72:73], v7, s[24:27], s47 offen offset:0 sc1
    buffer_load_dwordx2 v[74:75], v7, s[24:27], s47 offen offset:128 sc1
    buffer_load_dwordx2 v[76:77], v7, s[24:27], s47 offen offset:256 sc1
    buffer_load_dwordx2 v[78:79], v7, s[24:27], s47 offen offset:384 sc1
    v_cvt_pk_bf16_f32 v64, v28, v29
    v_cvt_pk_bf16_f32 v65, v30, v31
    v_cvt_pk_bf16_f32 v66, v32, v33
    v_cvt_pk_bf16_f32 v67, v34, v35
    v_cvt_pk_bf16_f32 v68, v36, v37
    v_cvt_pk_bf16_f32 v69, v38, v39
    buffer_store_dwordx2 v[68:69], v12, s[24:27], s44 offen offset:2048 sc1
    v_permlane32_swap_b32 v64, v66
    v_permlane32_swap_b32 v65, v67
    buffer_store_dwordx4 v[64:67], v4, s[24:27], s44 offen sc1
    s_waitcnt vmcnt(2)
    s_branch L_k4_chk
L_k4_poll:
    buffer_load_dwordx2 v[72:73], v7, s[24:27], s47 offen offset:0 sc1
    buffer_load_dwordx2 v[74:75], v7, s[24:27], s47 offen offset:128 sc1
    buffer_load_dwordx2 v[76:77], v7, s[24:27], s47 offen offset:256 sc1
    buffer_load_dwordx2 v[78:79], v7, s[24:27], s47 offen offset:384 sc1
    s_waitcnt vmcnt(0)
L_k4_chk:
    v_max3_u32 v12, v72, v73, v74
    v_max3_u32 v13, v75, v76, v77
    v_max3_u32 v12, v12, v78, v79
    v_max_u32 v12, v12, v13
    v_cmp_eq_u32 vcc, -1, v12
    s_add_u32 s54, s54, 1
    s_cmp_gt_u32 s54, 0x40000
    s_cbranch_scc1 L_k4_go
    s_cbranch_vccz L_k4_go
    s_sleep 2
    s_branch L_k4_poll
L_k4_go:
    v_add_f32 v72, v72, v74
    v_add_f32 v73, v73, v75
    v_add_f32 v76, v76, v78
    v_add_f32 v77, v77, v79
    v_add_f32 v72, v72, v76
    v_add_f32 v73, v73, v77
    v_mov_b32 v12, v72
    s_nop 1
    v_permlane32_swap_b32 v72, v12
    v_add_f32 v72, v72, v12
    v_mov_b32 v13, v73
    s_nop 1
    v_permlane32_swap_b32 v73, v13
    v_add_f32 v73, v73, v13
    v_mov_b32 v12, v72
    s_nop 1
    v_permlane16_swap_b32 v72, v12
    v_add_f32 v72, v72, v12
    v_mov_b32 v13, v73
    s_nop 1
    v_permlane16_swap_b32 v73, v13
    v_add_f32 v73, v73, v13
    v_mul_f32 v72, 0x3abe82fa, v72
    v_mul_f32 v73, 0x3abe82fa, v73
    v_fma_f32 v12, -v72, v72, v73
    v_max_f32 v12, 0, v12
    v_add_f32 v12, 0x3727c5ac, v12
    v_rsq_f32 v73, v12
    s_nop 0
    v_mul_f32 v72, -v72, v73
    v_add_u32 v12, 0, v3
    ds_bpermute_b32 v96, v12, v72
    ds_bpermute_b32 v100, v12, v73
    v_add_u32 v12, 4, v3
    ds_bpermute_b32 v97, v12, v72
    ds_bpermute_b32 v101, v12, v73
    v_add_u32 v12, 8, v3
    ds_bpermute_b32 v98, v12, v72
    ds_bpermute_b32 v102, v12, v73
    v_add_u32 v12, 12, v3
    ds_bpermute_b32 v99, v12, v72
    ds_bpermute_b32 v103, v12, v73
    s_lshl_b32 s45, s36, 10
    s_add_u32 s45, s45, 9437184
    s_waitcnt lgkmcnt(0)
    v_fma_f32 v16, v16, v100, v96
    v_fma_f32 v17, v17, v101, v97
    v_fma_f32 v18, v18, v102, v98
    v_fma_f32 v19, v19, v103, v99
    v_fma_f32 v20, v20, v100, v96
    v_fma_f32 v21, v21, v101, v97
    v_fma_f32 v22, v22, v102, v98
    v_fma_f32 v23, v23, v103, v99
    v_fma_f32 v24, v24, v100, v96
    v_fma_f32 v25, v25, v101, v97
    v_fma_f32 v26, v26, v102, v98
    v_fma_f32 v27, v27, v103, v99
    s_add_u32 s44, s31, 0
    s_lshr_b32 s46, s44, 1
    s_lshl_b32 s46, s46, 17
    s_and_b32 s44, s44, 1
    s_lshl_b32 s44, s44, 8
    s_add_u32 s44, s44, s46
    s_add_u32 s44, s44, s45
    v_cvt_pk_bf16_f32 v80, v16, v17
    v_cvt_pk_bf16_f32 v81, v18, v19
    s_mov_b32 s38, s44
    s_add_u32 s44, s31, 1
    s_lshr_b32 s46, s44, 1
    s_lshl_b32 s46, s46, 17
    s_and_b32 s44, s44, 1
    s_lshl_b32 s44, s44, 8
    s_add_u32 s44, s44, s46
    s_add_u32 s44, s44, s45
    v_cvt_pk_bf16_f32 v82, v20, v21
    v_cvt_pk_bf16_f32 v83, v22, v23
    s_nop 0
    v_permlane16_swap_b32 v80, v82
    v_permlane16_swap_b32 v81, v83
    buffer_store_dwordx4 v[80:83], v5, s[24:27], s38 offen sc1
    s_add_u32 s44, s31, 2
    s_lshr_b32 s46, s44, 1
    s_lshl_b32 s46, s46, 17
    s_and_b32 s44, s44, 1
    s_lshl_b32 s44, s44, 8
    s_add_u32 s44, s44, s46
    s_add_u32 s44, s44, s45
    v_cvt_pk_bf16_f32 v84, v24, v25
    v_cvt_pk_bf16_f32 v85, v26, v27
    buffer_store_dwordx2 v[84:85], v6, s[24:27], s44 offen sc1
L_z_done:
    s_load_dwordx2 s[6:7], s[0:1], 64
    s_load_dwordx2 s[10:11], s[0:1], 80
    s_mul_i32 s34, s57, 3
    s_min_u32 s34, s34, 19
    s_add_u32 s34, s34, s28
    s_lshl_b32 s62, s56, 12
    s_add_u32 s62, s62, 20512768
    s_lshl_b32 s52, s34, 7
    s_add_u32 s52, s52, s62
    s_mul_i32 s53, s61, 1408
    s_add_u32 s62, s62, s53
    s_lshl_b32 s40, s34, 17
    s_add_u32 s41, s40, 9437184
    s_mov_b32 s40, s41
    s_mov_b32 s45, 0
    s_mul_i32 s39, s56, 88
    s_lshl_b32 s42, s34, 1
    s_add_u32 s39, s39, s42
    s_lshl_b32 s39, s39, 10
    v_and_b32 v15, 31, v1
    v_lshlrev_b32 v12, 1, v15
    s_lshl_b32 s43, s56, 7
    s_waitcnt vmcnt(0) lgkmcnt(0)
    s_barrier
    s_cmp_lt_u32 s28, 3
    s_cbranch_scc1 L_k5_comp
    s_cmp_eq_u32 s28, 3
    s_cbranch_scc0 L_k5_idle
    s_lshl_b32 s44, s29, 4
    s_add_u32 s44, s44, s30
    s_lshl_b32 s44, s44, 7
    s_add_u32 s44, s44, 20480000
    v_mov_b32 v12, s58
    v_mov_b32 v13, s59
    v_mov_b32 v15, 0
    s_mov_b64 exec, 1
    buffer_store_dwordx2 v[12:13], v15, s[24:27], s44 offen sc1
    s_mov_b64 exec, -1
    s_lshl_b32 s44, s57, 1
    s_min_u32 s44, s44, 12
    s_lshl_b32 s44, s44, 7
    s_add_u32 s44, s44, 20480000
    v_and_b32 v15, 7, v1
    v_lshlrev_b32 v15, 12, v15
    v_lshrrev_b32 v12, 3, v1
    v_min_u32 v12, 2, v12
    v_lshl_add_u32 v15, v12, 7, v15
    s_mov_b32 s60, 0
L_poll_z:
    buffer_load_dwordx2 v[12:13], v15, s[24:27], s44 offen sc1
    s_add_u32 s60, s60, 1
    s_waitcnt vmcnt(0)
    v_xor_b32 v12, s58, v12
    v_xor_b32 v13, s59, v13
    v_or_b32 v12, v12, v13
    v_cmp_ne_u32 vcc, 0, v12
    s_cmp_gt_u32 s60, 0x40000
    s_cbranch_scc1 L_pollok_z
    s_cbranch_vccz L_pollok_z
    s_sleep 2
    s_branch L_poll_z
L_pollok_z:
    s_mov_b64 exec, -1
    s_barrier
    s_barrier
    s_barrier
    s_barrier
    s_barrier
    s_barrier
    s_add_u32 s44, s44, 2048
    s_mov_b32 s60, 0
L_poll_z2:
    buffer_load_dwordx2 v[12:13], v15, s[24:27], s44 offen sc1
    s_add_u32 s60, s60, 1
    s_waitcnt vmcnt(0)
    v_xor_b32 v12, s58, v12
    v_xor_b32 v13, s59, v13
    v_or_b32 v12, v12, v13
    v_cmp_ne_u32 vcc, 0, v12
    s_cmp_gt_u32 s60, 0x40000
    s_cbranch_scc1 L_pollok_z2
    s_cbranch_vccz L_pollok_z2
    s_sleep 2
    s_branch L_poll_z2
L_pollok_z2:
    s_mov_b64 exec, -1
    s_mov_b32 s55, 6
    s_branch L_k5_ib
L_k5_idle:
    s_mov_b32 s55, 0
L_k5_ib:
    s_barrier
    s_add_u32 s55, s55, 1
    s_cmp_lt_u32 s55, 17
    s_cbranch_scc1 L_k5_ib
    s_branch L_k6
L_k5_comp:
    s_mov_b32 s20, s6
    s_mov_b32 s21, s7
    s_mov_b32 s22, 0x1000
    s_mov_b32 s23, 0x00020000
    buffer_load_ushort v8, v12, s[20:23], s43 offen
    buffer_load_ushort v9, v12, s[20:23], s43 offen offset:64
    v_lshrrev_b32 v13, 1, v15
    v_and_b32 v13, 7, v13
    v_lshlrev_b32 v12, 7, v15
    v_lshrrev_b32 v10, 5, v1
    v_add_u32 v14, 0, v10
    v_xor_b32 v14, v14, v13
    v_lshl_add_u32 v4, v14, 4, v12
    v_add_u32 v14, 2, v10
    v_xor_b32 v14, v14, v13
    v_lshl_add_u32 v5, v14, 4, v12
    v_add_u32 v14, 4, v10
    v_xor_b32 v14, v14, v13
    v_lshl_add_u32 v6, v14, 4, v12
    v_add_u32 v14, 6, v10
    v_xor_b32 v14, v14, v13
    v_lshl_add_u32 v7, v14, 4, v12
    s_cmp_eq_u32 s34, 21
    s_cselect_b32 s44, 767, -1
    v_and_b32 v3, s44, v2
    s_mov_b32 s55, 0
    s_mov_b32 s54, 49152
    s_waitcnt vmcnt(0)
    v_lshlrev_b32 v8, 16, v8
    v_lshlrev_b32 v9, 16, v9
    v_mov_b32 v16, v8
    v_mov_b32 v32, v9
    v_mov_b32 v17, v8
    v_mov_b32 v33, v9
    v_mov_b32 v18, v8
    v_mov_b32 v34, v9
    v_mov_b32 v19, v8
    v_mov_b32 v35, v9
    v_mov_b32 v20, v8
    v_mov_b32 v36, v9
    v_mov_b32 v21, v8
    v_mov_b32 v37, v9
    v_mov_b32 v22, v8
    v_mov_b32 v38, v9
    v_mov_b32 v23, v8
    v_mov_b32 v39, v9
    v_mov_b32 v24, v8
    v_mov_b32 v40, v9
    v_mov_b32 v25, v8
    v_mov_b32 v41, v9
    v_mov_b32 v26, v8
    v_mov_b32 v42, v9
    v_mov_b32 v27, v8
    v_mov_b32 v43, v9
    v_mov_b32 v28, v8
    v_mov_b32 v44, v9
    v_mov_b32 v29, v8
    v_mov_b32 v45, v9
    v_mov_b32 v30, v8
    v_mov_b32 v46, v9
    v_mov_b32 v31, v8
    v_mov_b32 v47, v9
    s_barrier
    buffer_load_dwordx4 v[80:83], v3, s[24:27], s40 offen offset:0 sc1
    buffer_load_dwordx4 v[84:87], v3, s[24:27], s40 offen offset:1024 sc1
    buffer_load_dwordx4 v[88:91], v3, s[24:27], s40 offen offset:2048 sc1
    buffer_load_dwordx4 v[92:95], v3, s[24:27], s40 offen offset:3072 sc1
    s_add_u32 s40, s40, 4096
    buffer_load_dwordx4 v[96:99], v3, s[24:27], s40 offen offset:0 sc1
    buffer_load_dwordx4 v[100:103], v3, s[24:27], s40 offen offset:1024 sc1
    buffer_load_dwordx4 v[104:107], v3, s[24:27], s40 offen offset:2048 sc1
    buffer_load_dwordx4 v[108:111], v3, s[24:27], s40 offen offset:3072 sc1
    s_add_u32 s40, s40, 12288
    buffer_load_dwordx4 v[112:115], v3, s[24:27], s40 offen offset:0 sc1
    buffer_load_dwordx4 v[116:119], v3, s[24:27], s40 offen offset:1024 sc1
    buffer_load_dwordx4 v[120:123], v3, s[24:27], s40 offen offset:2048 sc1
    buffer_load_dwordx4 v[124:127], v3, s[24:27], s40 offen offset:3072 sc1
    s_add_u32 s40, s40, 4096
    s_add_u32 s41, s41, 8192
    s_add_u32 s45, s39, 6291456
    s_barrier
    ds_read_b128 v[48:51], v4 offset:0
    ds_read_b128 v[52:55], v4 offset:4096
    ds_read_b128 v[56:59], v5 offset:0
    ds_read_b128 v[60:63], v5 offset:4096
L_k5_loop:
    ds_read_b128 v[64:67], v6 offset:0
    ds_read_b128 v[68:71], v6 offset:4096
    ds_read_b128 v[72:75], v7 offset:0
    ds_read_b128 v[76:79], v7 offset:4096
    s_waitcnt vmcnt(10) lgkmcnt(4)
    v_mfma_f32_32x32x16_bf16 v[16:31], v[80:83], v[48:51], v[16:31]
    v_mfma_f32_32x32x16_bf16 v[32:47], v[80:83], v[52:55], v[32:47]
    buffer_load_dwordx4 v[80:83], v3, s[24:27], s40 offen offset:0 sc1
    v_mfma_f32_32x32x16_bf16 v[16:31], v[84:87], v[56:59], v[16:31]
    v_mfma_f32_32x32x16_bf16 v[32:47], v[84:87], v[60:63], v[32:47]
    buffer_load_dwordx4 v[84:87], v3, s[24:27], s40 offen offset:1024 sc1
    ds_read_b128 v[48:51], v4 offset:8192
    ds_read_b128 v[52:55], v4 offset:12288
    ds_read_b128 v[56:59], v5 offset:8192
    ds_read_b128 v[60:63], v5 offset:12288
    s_waitcnt vmcnt(10) lgkmcnt(4)
    v_mfma_f32_32x32x16_bf16 v[16:31], v[88:91], v[64:67], v[16:31]
    v_mfma_f32_32x32x16_bf16 v[32:47], v[88:91], v[68:71], v[32:47]
    buffer_load_dwordx4 v[88:91], v3, s[24:27], s40 offen offset:2048 sc1
    v_mfma_f32_32x32x16_bf16 v[16:31], v[92:95], v[72:75], v[16:31]
    v_mfma_f32_32x32x16_bf16 v[32:47], v[92:95], v[76:79], v[32:47]
    buffer_load_dwordx4 v[92:95], v3, s[24:27], s40 offen offset:3072 sc1
    s_add_u32 s40, s40, 12288
    s_cmp_eq_u32 s55, 2
    s_cselect_b32 s40, s41, s40
    ds_read_b128 v[64:67], v6 offset:8192
    ds_read_b128 v[68:71], v6 offset:12288
    ds_read_b128 v[72:75], v7 offset:8192
    ds_read_b128 v[76:79], v7 offset:12288
    s_waitcnt vmcnt(10) lgkmcnt(4)
    v_mfma_f32_32x32x16_bf16 v[16:31], v[96:99], v[48:51], v[16:31]
    v_mfma_f32_32x32x16_bf16 v[32:47], v[96:99], v[52:55], v[32:47]
    buffer_load_dwordx4 v[96:99], v3, s[24:27], s40 offen offset:0 sc1
    v_mfma_f32_32x32x16_bf16 v[16:31], v[100:103], v[56:59], v[16:31]
    v_mfma_f32_32x32x16_bf16 v[32:47], v[100:103], v[60:63], v[32:47]
    buffer_load_dwordx4 v[100:103], v3, s[24:27], s40 offen offset:1024 sc1
    s_waitcnt vmcnt(10) lgkmcnt(0)
    s_barrier
    ds_read_b128 v[48:51], v4 offset:16384
    ds_read_b128 v[52:55], v4 offset:20480
    ds_read_b128 v[56:59], v5 offset:16384
    ds_read_b128 v[60:63], v5 offset:20480
    v_mfma_f32_32x32x16_bf16 v[16:31], v[104:107], v[64:67], v[16:31]
    v_mfma_f32_32x32x16_bf16 v[32:47], v[104:107], v[68:71], v[32:47]
    buffer_load_dwordx4 v[104:107], v3, s[24:27], s40 offen offset:2048 sc1
    v_mfma_f32_32x32x16_bf16 v[16:31], v[108:111], v[72:75], v[16:31]
    v_mfma_f32_32x32x16_bf16 v[32:47], v[108:111], v[76:79], v[32:47]
    buffer_load_dwordx4 v[108:111], v3, s[24:27], s40 offen offset:3072 sc1
    s_add_u32 s40, s40, 4096
    ds_read_b128 v[64:67], v6 offset:16384
    ds_read_b128 v[68:71], v6 offset:20480
    ds_read_b128 v[72:75], v7 offset:16384
    ds_read_b128 v[76:79], v7 offset:20480
    s_waitcnt vmcnt(10) lgkmcnt(4)
    v_mfma_f32_32x32x16_bf16 v[16:31], v[112:115], v[48:51], v[16:31]
    v_mfma_f32_32x32x16_bf16 v[32:47], v[112:115], v[52:55], v[32:47]
    buffer_load_dwordx4 v[112:115], v3, s[24:27], s40 offen offset:0 sc1
    v_mfma_f32_32x32x16_bf16 v[16:31], v[116:119], v[56:59], v[16:31]
    v_mfma_f32_32x32x16_bf16 v[32:47], v[116:119], v[60:63], v[32:47]
    buffer_load_dwordx4 v[116:119], v3, s[24:27], s40 offen offset:1024 sc1
    ds_read_b128 v[48:51], v4 offset:24576
    ds_read_b128 v[52:55], v4 offset:28672
    ds_read_b128 v[56:59], v5 offset:24576
    ds_read_b128 v[60:63], v5 offset:28672
    s_waitcnt vmcnt(10) lgkmcnt(4)
    v_mfma_f32_32x32x16_bf16 v[16:31], v[120:123], v[64:67], v[16:31]
    v_mfma_f32_32x32x16_bf16 v[32:47], v[120:123], v[68:71], v[32:47]
    buffer_load_dwordx4 v[120:123], v3, s[24:27], s40 offen offset:2048 sc1
    v_mfma_f32_32x32x16_bf16 v[16:31], v[124:127], v[72:75], v[16:31]
    v_mfma_f32_32x32x16_bf16 v[32:47], v[124:127], v[76:79], v[32:47]
    buffer_load_dwordx4 v[124:127], v3, s[24:27], s40 offen offset:3072 sc1
    s_add_u32 s40, s40, 12288
    ds_read_b128 v[64:67], v6 offset:24576
    ds_read_b128 v[68:71], v6 offset:28672
    ds_read_b128 v[72:75], v7 offset:24576
    ds_read_b128 v[76:79], v7 offset:28672
    s_waitcnt vmcnt(10) lgkmcnt(4)
    v_mfma_f32_32x32x16_bf16 v[16:31], v[80:83], v[48:51], v[16:31]
    v_mfma_f32_32x32x16_bf16 v[32:47], v[80:83], v[52:55], v[32:47]
    buffer_load_dwordx4 v[80:83], v3, s[24:27], s40 offen offset:0 sc1
    v_mfma_f32_32x32x16_bf16 v[16:31], v[84:87], v[56:59], v[16:31]
    v_mfma_f32_32x32x16_bf16 v[32:47], v[84:87], v[60:63], v[32:47]
    buffer_load_dwordx4 v[84:87], v3, s[24:27], s40 offen offset:1024 sc1
    s_waitcnt vmcnt(10) lgkmcnt(0)
    s_barrier
    ds_read_b128 v[48:51], v4 offset:32768
    ds_read_b128 v[52:55], v4 offset:36864
    ds_read_b128 v[56:59], v5 offset:32768
    ds_read_b128 v[60:63], v5 offset:36864
    v_mfma_f32_32x32x16_bf16 v[16:31], v[88:91], v[64:67], v[16:31]
    v_mfma_f32_32x32x16_bf16 v[32:47], v[88:91], v[68:71], v[32:47]
    buffer_load_dwordx4 v[88:91], v3, s[24:27], s40 offen offset:2048 sc1
    v_mfma_f32_32x32x16_bf16 v[16:31], v[92:95], v[72:75], v[16:31]
    v_mfma_f32_32x32x16_bf16 v[32:47], v[92:95], v[76:79], v[32:47]
    buffer_load_dwordx4 v[92:95], v3, s[24:27], s40 offen offset:3072 sc1
    s_add_u32 s40, s40, 4096
    ds_read_b128 v[64:67], v6 offset:32768
    ds_read_b128 v[68:71], v6 offset:36864
    ds_read_b128 v[72:75], v7 offset:32768
    ds_read_b128 v[76:79], v7 offset:36864
    s_waitcnt vmcnt(10) lgkmcnt(4)
    v_mfma_f32_32x32x16_bf16 v[16:31], v[96:99], v[48:51], v[16:31]
    v_mfma_f32_32x32x16_bf16 v[32:47], v[96:99], v[52:55], v[32:47]
    buffer_load_dwordx4 v[96:99], v3, s[24:27], s40 offen offset:0 sc1
    v_mfma_f32_32x32x16_bf16 v[16:31], v[100:103], v[56:59], v[16:31]
    v_mfma_f32_32x32x16_bf16 v[32:47], v[100:103], v[60:63], v[32:47]
    buffer_load_dwordx4 v[100:103], v3, s[24:27], s40 offen offset:1024 sc1
    ds_read_b128 v[48:51], v4 offset:40960
    ds_read_b128 v[52:55], v4 offset:45056
    ds_read_b128 v[56:59], v5 offset:40960
    ds_read_b128 v[60:63], v5 offset:45056
    s_waitcnt vmcnt(10) lgkmcnt(4)
    v_mfma_f32_32x32x16_bf16 v[16:31], v[104:107], v[64:67], v[16:31]
    v_mfma_f32_32x32x16_bf16 v[32:47], v[104:107], v[68:71], v[32:47]
    buffer_load_dwordx4 v[104:107], v3, s[24:27], s40 offen offset:2048 sc1
    v_mfma_f32_32x32x16_bf16 v[16:31], v[108:111], v[72:75], v[16:31]
    v_mfma_f32_32x32x16_bf16 v[32:47], v[108:111], v[76:79], v[32:47]
    buffer_load_dwordx4 v[108:111], v3, s[24:27], s40 offen offset:3072 sc1
    s_add_u32 s40, s40, 12288
    s_add_u32 s55, s55, 1
    s_cmp_eq_u32 s55, 5
    s_cselect_b32 s40, s45, s40
    s_cselect_b32 s44, -1, 0
    v_and_or_b32 v3, s44, v2, v3
    ds_read_b128 v[64:67], v6 offset:40960
    ds_read_b128 v[68:71], v6 offset:45056
    ds_read_b128 v[72:75], v7 offset:40960
    ds_read_b128 v[76:79], v7 offset:45056
    s_waitcnt vmcnt(10) lgkmcnt(4)
    v_mfma_f32_32x32x16_bf16 v[16:31], v[112:115], v[48:51], v[16:31]
    v_mfma_f32_32x32x16_bf16 v[32:47], v[112:115], v[52:55], v[32:47]
    buffer_load_dwordx4 v[112:115], v3, s[24:27], s40 offen offset:0 sc1
    v_mfma_f32_32x32x16_bf16 v[16:31], v[116:119], v[56:59], v[16:31]
    v_mfma_f32_32x32x16_bf16 v[32:47], v[116:119], v[60:63], v[32:47]
    buffer_load_dwordx4 v[116:119], v3, s[24:27], s40 offen offset:1024 sc1
    s_waitcnt vmcnt(10) lgkmcnt(0)
    s_barrier
    ds_read_b128 v[48:51], v4 offset:0
    ds_read_b128 v[52:55], v4 offset:4096
    ds_read_b128 v[56:59], v5 offset:0
    ds_read_b128 v[60:63], v5 offset:4096
    v_mfma_f32_32x32x16_bf16 v[16:31], v[120:123], v[64:67], v[16:31]
    v_mfma_f32_32x32x16_bf16 v[32:47], v[120:123], v[68:71], v[32:47]
    buffer_load_dwordx4 v[120:123], v3, s[24:27], s40 offen offset:2048 sc1
    v_mfma_f32_32x32x16_bf16 v[16:31], v[124:127], v[72:75], v[16:31]
    v_mfma_f32_32x32x16_bf16 v[32:47], v[124:127], v[76:79], v[32:47]
    buffer_load_dwordx4 v[124:127], v3, s[24:27], s40 offen offset:3072 sc1
    s_add_u32 s40, s40, 4096
    s_cmp_lt_u32 s55, 5
    s_cbranch_scc1 L_k5_loop
    s_add_u32 s43, s39, 6336512
    ds_read_b128 v[64:67], v6 offset:0
    ds_read_b128 v[68:71], v6 offset:4096
    ds_read_b128 v[72:75], v7 offset:0
    ds_read_b128 v[76:79], v7 offset:4096
    s_waitcnt vmcnt(10) lgkmcnt(4)
    v_mfma_f32_32x32x16_bf16 v[16:31], v[80:83], v[48:51], v[16:31]
    v_mfma_f32_32x32x16_bf16 v[32:47], v[80:83], v[52:55], v[32:47]
    buffer_load_dwordx4 v[80:83], v2, s[24:27], s43 offen offset:0 sc1
    v_mfma_f32_32x32x16_bf16 v[16:31], v[84:87], v[56:59], v[16:31]
    v_mfma_f32_32x32x16_bf16 v[32:47], v[84:87], v[60:63], v[32:47]
    buffer_load_dwordx4 v[84:87], v2, s[24:27], s43 offen offset:1024 sc1
    ds_read_b128 v[48:51], v4 offset:8192
    ds_read_b128 v[52:55], v4 offset:12288
    ds_read_b128 v[56:59], v5 offset:8192
    ds_read_b128 v[60:63], v5 offset:12288
    s_waitcnt vmcnt(10) lgkmcnt(4)
    v_mfma_f32_32x32x16_bf16 v[16:31], v[88:91], v[64:67], v[16:31]
    v_mfma_f32_32x32x16_bf16 v[32:47], v[88:91], v[68:71], v[32:47]
    v_mfma_f32_32x32x16_bf16 v[16:31], v[92:95], v[72:75], v[16:31]
    v_mfma_f32_32x32x16_bf16 v[32:47], v[92:95], v[76:79], v[32:47]
    ds_read_b128 v[64:67], v6 offset:8192
    ds_read_b128 v[68:71], v6 offset:12288
    ds_read_b128 v[72:75], v7 offset:8192
    ds_read_b128 v[76:79], v7 offset:12288
    s_waitcnt vmcnt(8) lgkmcnt(4)
    v_mfma_f32_32x32x16_bf16 v[16:31], v[96:99], v[48:51], v[16:31]
    v_mfma_f32_32x32x16_bf16 v[32:47], v[96:99], v[52:55], v[32:47]
    v_mfma_f32_32x32x16_bf16 v[16:31], v[100:103], v[56:59], v[16:31]
    v_mfma_f32_32x32x16_bf16 v[32:47], v[100:103], v[60:63], v[32:47]
    s_waitcnt vmcnt(6) lgkmcnt(0)
    v_mfma_f32_32x32x16_bf16 v[16:31], v[104:107], v[64:67], v[16:31]
    v_mfma_f32_32x32x16_bf16 v[32:47], v[104:107], v[68:71], v[32:47]
    v_mfma_f32_32x32x16_bf16 v[16:31], v[108:111], v[72:75], v[16:31]
    v_mfma_f32_32x32x16_bf16 v[32:47], v[108:111], v[76:79], v[32:47]
    s_cmp_eq_u32 s57, 7
    s_cselect_b32 s44, 2, 0
    s_cmp_lt_u32 s28, s44
    s_cbranch_scc1 L_k6_exit
    s_add_u32 s42, s39, 12582912
    s_add_u32 s43, s42, 45056
    s_waitcnt vmcnt(0)
    v_lshlrev_b32 v48, 16, v112
    v_and_b32 v49, 0xffff0000, v112
    v_lshlrev_b32 v50, 16, v113
    v_and_b32 v51, 0xffff0000, v113
    v_lshlrev_b32 v52, 16, v114
    v_and_b32 v53, 0xffff0000, v114
    v_lshlrev_b32 v54, 16, v115
    v_and_b32 v55, 0xffff0000, v115
    v_lshlrev_b32 v56, 16, v116
    v_and_b32 v57, 0xffff0000, v116
    v_lshlrev_b32 v58, 16, v117
    v_and_b32 v59, 0xffff0000, v117
    v_lshlrev_b32 v60, 16, v118
    v_and_b32 v61, 0xffff0000, v118
    v_lshlrev_b32 v62, 16, v119
    v_and_b32 v63, 0xffff0000, v119
    v_lshlrev_b32 v64, 16, v80
    v_and_b32 v65, 0xffff0000, v80
    v_lshlrev_b32 v66, 16, v81
    v_and_b32 v67, 0xffff0000, v81
    v_lshlrev_b32 v68, 16, v82
    v_and_b32 v69, 0xffff0000, v82
    v_lshlrev_b32 v70, 16, v83
    v_and_b32 v71, 0xffff0000, v83
    v_lshlrev_b32 v72, 16, v84
    v_and_b32 v73, 0xffff0000, v84
    v_lshlrev_b32 v74, 16, v85
    v_and_b32 v75, 0xffff0000, v85
    v_lshlrev_b32 v76, 16, v86
    v_and_b32 v77, 0xffff0000, v86
    v_lshlrev_b32 v78, 16, v87
    v_and_b32 v79, 0xffff0000, v87
    v_mul_f32 v16, v16, v48
    v_mul_f32 v17, v17, v49
    v_mul_f32 v18, v18, v50
    v_mul_f32 v19, v19, v51
    v_mul_f32 v20, v20, v52
    v_mul_f32 v21, v21, v53
    v_mul_f32 v22, v22, v54
    v_mul_f32 v23, v23, v55
    v_mul_f32 v24, v24, v56
    v_mul_f32 v25, v25, v57
    v_mul_f32 v26, v26, v58
    v_mul_f32 v27, v27, v59
    v_mul_f32 v28, v28, v60
    v_mul_f32 v29, v29, v61
    v_mul_f32 v30, v30, v62
    v_mul_f32 v31, v31, v63
    v_mul_f32 v32, v32, v64
    v_mul_f32 v33, v33, v65
    v_mul_f32 v34, v34, v66
    v_mul_f32 v35, v35, v67
    v_mul_f32 v36, v36, v68
    v_mul_f32 v37, v37, v69
    v_mul_f32 v38, v38, v70
    v_mul_f32 v39, v39, v71
    v_mul_f32 v40, v40, v72
    v_mul_f32 v41, v41, v73
    v_mul_f32 v42, v42, v74
    v_mul_f32 v43, v43, v75
    v_mul_f32 v44, v44, v76
    v_mul_f32 v45, v45, v77
    v_mul_f32 v46, v46, v78
    v_mul_f32 v47, v47, v79
    v_cvt_pk_bf16_f32 v80, v16, v17
    v_cvt_pk_bf16_f32 v81, v18, v19
    v_cvt_pk_bf16_f32 v82, v20, v21
    v_cvt_pk_bf16_f32 v83, v22, v23
    v_cvt_pk_bf16_f32 v84, v24, v25
    v_cvt_pk_bf16_f32 v85, v26, v27
    v_cvt_pk_bf16_f32 v86, v28, v29
    v_cvt_pk_bf16_f32 v87, v30, v31
    v_cvt_pk_bf16_f32 v88, v32, v33
    v_cvt_pk_bf16_f32 v89, v34, v35
    v_cvt_pk_bf16_f32 v90, v36, v37
    v_cvt_pk_bf16_f32 v91, v38, v39
    v_cvt_pk_bf16_f32 v92, v40, v41
    v_cvt_pk_bf16_f32 v93, v42, v43
    v_cvt_pk_bf16_f32 v94, v44, v45
    v_cvt_pk_bf16_f32 v95, v46, v47
    buffer_store_dwordx4 v[80:83], v2, s[24:27], s42 offen offset:0 sc1
    buffer_store_dwordx4 v[84:87], v2, s[24:27], s42 offen offset:1024 sc1
    buffer_store_dwordx4 v[88:91], v2, s[24:27], s43 offen offset:0 sc1
    buffer_store_dwordx4 v[92:95], v2, s[24:27], s43 offen offset:1024 sc1
    s_waitcnt vmcnt(0)
    v_mov_b32 v12, s58
    v_mov_b32 v13, s59
    v_mov_b32 v15, 0
    s_mov_b64 exec, 1
    s_cmp_lg_u32 s63, 0
    s_cbranch_scc1 L_sequential_preLN__grouped_kv_mqa__mixer_gmlp__prompt_kernel_hs_7
    buffer_store_dwordx2 v[12:13], v15, s[24:27], s52 offen sc1
    s_branch L_sequential_preLN__grouped_kv_mqa__mixer_gmlp__prompt_kernel_hs_8
L_sequential_preLN__grouped_kv_mqa__mixer_gmlp__prompt_kernel_hs_7:
    buffer_store_dwordx2 v[12:13], v15, s[24:27], s52 offen
L_sequential_preLN__grouped_kv_mqa__mixer_gmlp__prompt_kernel_hs_8:
    s_mov_b64 exec, -1
    s_endpgm
L_k6:
    s_cmp_eq_u32 s28, 3
    s_cbranch_scc1 L_k6_exit
    s_load_dwordx2 s[10:11], s[0:1], 80
    s_lshr_b32 s61, s28, 3
    s_sub_u32 s48, s28, 4
    s_lshl_b32 s62, s56, 12
    s_add_u32 s62, s62, 20512768
    s_mul_i32 s53, s61, 1408
    s_add_u32 s62, s62, s53
    v_lshrrev_b32 v8, 4, v1
    v_lshrrev_b32 v9, 5, v1
    v_lshrrev_b32 v10, 2, v1
    v_and_b32 v10, 3, v10
    v_and_b32 v11, 3, v1
    s_lshl_b32 s36, s56, 2
    s_add_u32 s36, s36, s3
    s_lshl_b32 s37, s57, 1
    s_add_u32 s37, s37, s61
    s_lshl_b32 s47, s36, 4
    s_add_u32 s47, s47, s37
    s_lshl_b32 s47, s47, 10
    s_add_u32 s47, s47, 4194304
    buffer_load_dwordx4 v[112:115], v2, s[24:27], s47 offen sc1
    s_mul_i32 s45, s61, 11264
    s_add_u32 s45, s45, 73728
    v_add_u32 v4, s45, v2
    v_add_u32 v5, 45056, v4
    v_lshrrev_b32 v12, 1, v8
    v_lshlrev_b32 v3, 10, v12
    v_and_b32 v12, 1, v8
    v_lshl_add_u32 v3, v12, 9, v3
    v_and_b32 v12, 15, v1
    v_lshl_add_u32 v3, v12, 4, v3
    s_lshl_b32 s60, s32, 8
    v_add_u32 v3, s60, v3
    s_lshr_b32 s46, s36, 1
    s_mul_i32 s46, s46, 45056
    s_mul_i32 s47, s61, 22528
    s_add_u32 s46, s46, s47
    s_add_u32 s46, s46, 12582912
    s_cmp_eq_u32 s61, 0
    s_cselect_b32 s49, -1, 0
    s_waitcnt lgkmcnt(0)
    s_mov_b32 s16, s10
    s_mov_b32 s17, s11
    s_mov_b32 s18, 0x200000
    s_mov_b32 s19, 0x00020000
    v_mov_b32 v16, 0
    v_mov_b32 v17, 0
    v_mov_b32 v18, 0
    v_mov_b32 v19, 0
    v_mov_b32 v20, 0
    v_mov_b32 v21, 0
    v_mov_b32 v22, 0
    v_mov_b32 v23, 0
    v_mov_b32 v24, 0
    v_mov_b32 v25, 0
    v_mov_b32 v26, 0
    v_mov_b32 v27, 0
    v_mov_b32 v28, 0
    v_mov_b32 v29, 0
    v_mov_b32 v30, 0
    v_mov_b32 v31, 0
    v_mov_b32 v104, 0
    v_mov_b32 v105, 0
    v_mov_b32 v106, 0
    v_mov_b32 v107, 0
    ds_read_b128 v[32:35], v4 offset:0
    ds_read_b128 v[36:39], v4 offset:22528
    ds_read_b128 v[40:43], v5 offset:0
    ds_read_b128 v[44:47], v5 offset:22528
    v_lshlrev_b32 v15, 7, v1
    s_mov_b64 exec, 0x7ff
    s_mov_b32 s60, 0
L_poll_y:
    buffer_load_dwordx2 v[12:13], v15, s[24:27], s62 offen sc1
    s_add_u32 s60, s60, 1
    s_waitcnt vmcnt(0)
    v_xor_b32 v12, s58, v12
    v_xor_b32 v13, s59, v13
    v_or_b32 v12, v12, v13
    v_cmp_ne_u32 vcc, 0, v12
    s_cmp_gt_u32 s60, 0x40000
    s_cbranch_scc1 L_pollok_y
    s_cbranch_vccz L_pollok_y
    s_sleep 2
    s_branch L_poll_y
L_pollok_y:
    s_mov_b64 exec, -1
    s_add_u32 s47, s46, 0
    buffer_load_dwordx4 v[64:67], v3, s[24:27], s47 offen offset:0 sc1
    buffer_load_dwordx4 v[68:71], v3, s[24:27], s47 offen offset:2048 sc1
    s_add_u32 s47, s46, 4096
    buffer_load_dwordx4 v[72:75], v3, s[24:27], s47 offen offset:0 sc1
    buffer_load_dwordx4 v[76:79], v3, s[24:27], s47 offen offset:2048 sc1
    s_add_u32 s47, s46, 8192
    buffer_load_dwordx4 v[80:83], v3, s[24:27], s47 offen offset:0 sc1
    buffer_load_dwordx4 v[84:87], v3, s[24:27], s47 offen offset:2048 sc1
    s_add_u32 s47, s46, 12288
    buffer_load_dwordx4 v[88:91], v3, s[24:27], s47 offen offset:0 sc1
    buffer_load_dwordx4 v[92:95], v3, s[24:27], s47 offen offset:2048 sc1
    s_add_u32 s47, s46, 16384
    buffer_load_dwordx4 v[96:99], v3, s[24:27], s47 offen offset:0 sc1
    buffer_load_dwordx4 v[100:103], v3, s[24:27], s47 offen offset:2048 sc1
    s_add_u32 s47, s46, 20480
    s_mov_b32 exec_hi, s49
    buffer_load_dwordx4 v[104:107], v3, s[24:27], s47 offen offset:0 sc1
    s_mov_b32 exec_hi, -1
    ds_read_b128 v[48:51], v4 offset:1024
    ds_read_b128 v[52:55], v4 offset:23552
    ds_read_b128 v[56:59], v5 offset:1024
    ds_read_b128 v[60:63], v5 offset:23552
    s_waitcnt vmcnt(10) lgkmcnt(7)
    v_mfma_f32_16x16x32_bf16 v[16:19], v[32:35], v[64:67], v[16:19]
    ds_read_b128 v[32:35], v4 offset:2048
    s_waitcnt lgkmcnt(7)
    v_mfma_f32_16x16x32_bf16 v[20:23], v[36:39], v[64:67], v[20:23]
    ds_read_b128 v[36:39], v4 offset:24576
    s_waitcnt lgkmcnt(7)
    v_mfma_f32_16x16x32_bf16 v[24:27], v[40:43], v[64:67], v[24:27]
    ds_read_b128 v[40:43], v5 offset:2048
    s_waitcnt lgkmcnt(7)
    v_mfma_f32_16x16x32_bf16 v[28:31], v[44:47], v[64:67], v[28:31]
    ds_read_b128 v[44:47], v5 offset:24576
    s_waitcnt vmcnt(9) lgkmcnt(7)
    v_mfma_f32_16x16x32_bf16 v[16:19], v[48:51], v[68:71], v[16:19]
    ds_read_b128 v[48:51], v4 offset:3072
    s_waitcnt lgkmcnt(7)
    v_mfma_f32_16x16x32_bf16 v[20:23], v[52:55], v[68:71], v[20:23]
    ds_read_b128 v[52:55], v4 offset:25600
    s_waitcnt lgkmcnt(7)
    v_mfma_f32_16x16x32_bf16 v[24:27], v[56:59], v[68:71], v[24:27]
    ds_read_b128 v[56:59], v5 offset:3072
    s_waitcnt lgkmcnt(7)
    v_mfma_f32_16x16x32_bf16 v[28:31], v[60:63], v[68:71], v[28:31]
    ds_read_b128 v[60:63], v5 offset:25600
    s_waitcnt vmcnt(8) lgkmcnt(7)
    v_mfma_f32_16x16x32_bf16 v[16:19], v[32:35], v[72:75], v[16:19]
    ds_read_b128 v[32:35], v4 offset:4096
    s_waitcnt lgkmcnt(7)
    v_mfma_f32_16x16x32_bf16 v[20:23], v[36:39], v[72:75], v[20:23]
    ds_read_b128 v[36:39], v4 offset:26624
    s_waitcnt lgkmcnt(7)
    v_mfma_f32_16x16x32_bf16 v[24:27], v[40:43], v[72:75], v[24:27]
    ds_read_b128 v[40:43], v5 offset:4096
    s_waitcnt lgkmcnt(7)
    v_mfma_f32_16x16x32_bf16 v[28:31], v[44:47], v[72:75], v[28:31]
    ds_read_b128 v[44:47], v5 offset:26624
    s_waitcnt vmcnt(7) lgkmcnt(7)
    v_mfma_f32_16x16x32_bf16 v[16:19], v[48:51], v[76:79], v[16:19]
    ds_read_b128 v[48:51], v4 offset:5120
    s_waitcnt lgkmcnt(7)
    v_mfma_f32_16x16x32_bf16 v[20:23], v[52:55], v[76:79], v[20:23]
    ds_read_b128 v[52:55], v4 offset:27648
    s_waitcnt lgkmcnt(7)
    v_mfma_f32_16x16x32_bf16 v[24:27], v[56:59], v[76:79], v[24:27]
    ds_read_b128 v[56:59], v5 offset:5120
    s_waitcnt lgkmcnt(7)
    v_mfma_f32_16x16x32_bf16 v[28:31], v[60:63], v[76:79], v[28:31]
    ds_read_b128 v[60:63], v5 offset:27648
    s_waitcnt vmcnt(6) lgkmcnt(7)
    v_mfma_f32_16x16x32_bf16 v[16:19], v[32:35], v[80:83], v[16:19]
    ds_read_b128 v[32:35], v4 offset:6144
    s_waitcnt lgkmcnt(7)
    v_mfma_f32_16x16x32_bf16 v[20:23], v[36:39], v[80:83], v[20:23]
    ds_read_b128 v[36:39], v4 offset:28672
    s_waitcnt lgkmcnt(7)
    v_mfma_f32_16x16x32_bf16 v[24:27], v[40:43], v[80:83], v[24:27]
    ds_read_b128 v[40:43], v5 offset:6144
    s_waitcnt lgkmcnt(7)
    v_mfma_f32_16x16x32_bf16 v[28:31], v[44:47], v[80:83], v[28:31]
    ds_read_b128 v[44:47], v5 offset:28672
    s_waitcnt vmcnt(5) lgkmcnt(7)
    v_mfma_f32_16x16x32_bf16 v[16:19], v[48:51], v[84:87], v[16:19]
    ds_read_b128 v[48:51], v4 offset:7168
    s_waitcnt lgkmcnt(7)
    v_mfma_f32_16x16x32_bf16 v[20:23], v[52:55], v[84:87], v[20:23]
    ds_read_b128 v[52:55], v4 offset:29696
    s_waitcnt lgkmcnt(7)
    v_mfma_f32_16x16x32_bf16 v[24:27], v[56:59], v[84:87], v[24:27]
    ds_read_b128 v[56:59], v5 offset:7168
    s_waitcnt lgkmcnt(7)
    v_mfma_f32_16x16x32_bf16 v[28:31], v[60:63], v[84:87], v[28:31]
    ds_read_b128 v[60:63], v5 offset:29696
    s_waitcnt vmcnt(4) lgkmcnt(7)
    v_mfma_f32_16x16x32_bf16 v[16:19], v[32:35], v[88:91], v[16:19]
    ds_read_b128 v[32:35], v4 offset:8192
    s_waitcnt lgkmcnt(7)
    v_mfma_f32_16x16x32_bf16 v[20:23], v[36:39], v[88:91], v[20:23]
    ds_read_b128 v[36:39], v4 offset:30720
    s_waitcnt lgkmcnt(7)
    v_mfma_f32_16x16x32_bf16 v[24:27], v[40:43], v[88:91], v[24:27]
    ds_read_b128 v[40:43], v5 offset:8192
    s_waitcnt lgkmcnt(7)
    v_mfma_f32_16x16x32_bf16 v[28:31], v[44:47], v[88:91], v[28:31]
    ds_read_b128 v[44:47], v5 offset:30720
    s_waitcnt vmcnt(3) lgkmcnt(7)
    v_mfma_f32_16x16x32_bf16 v[16:19], v[48:51], v[92:95], v[16:19]
    ds_read_b128 v[48:51], v4 offset:9216
    s_waitcnt lgkmcnt(7)
    v_mfma_f32_16x16x32_bf16 v[20:23], v[52:55], v[92:95], v[20:23]
    ds_read_b128 v[52:55], v4 offset:31744
    s_waitcnt lgkmcnt(7)
    v_mfma_f32_16x16x32_bf16 v[24:27], v[56:59], v[92:95], v[24:27]
    ds_read_b128 v[56:59], v5 offset:9216
    s_waitcnt lgkmcnt(7)
    v_mfma_f32_16x16x32_bf16 v[28:31], v[60:63], v[92:95], v[28:31]
    ds_read_b128 v[60:63], v5 offset:31744
    s_waitcnt vmcnt(2) lgkmcnt(7)
    v_mfma_f32_16x16x32_bf16 v[16:19], v[32:35], v[96:99], v[16:19]
    ds_read_b128 v[32:35], v4 offset:10240
    s_waitcnt lgkmcnt(7)
    v_mfma_f32_16x16x32_bf16 v[20:23], v[36:39], v[96:99], v[20:23]
    ds_read_b128 v[36:39], v4 offset:32768
    s_waitcnt lgkmcnt(7)
    v_mfma_f32_16x16x32_bf16 v[24:27], v[40:43], v[96:99], v[24:27]
    ds_read_b128 v[40:43], v5 offset:10240
    s_waitcnt lgkmcnt(7)
    v_mfma_f32_16x16x32_bf16 v[28:31], v[44:47], v[96:99], v[28:31]
    ds_read_b128 v[44:47], v5 offset:32768
    s_waitcnt vmcnt(1) lgkmcnt(7)
    v_mfma_f32_16x16x32_bf16 v[16:19], v[48:51], v[100:103], v[16:19]
    s_waitcnt lgkmcnt(6)
    v_mfma_f32_16x16x32_bf16 v[20:23], v[52:55], v[100:103], v[20:23]
    s_waitcnt lgkmcnt(5)
    v_mfma_f32_16x16x32_bf16 v[24:27], v[56:59], v[100:103], v[24:27]
    s_waitcnt lgkmcnt(4)
    v_mfma_f32_16x16x32_bf16 v[28:31], v[60:63], v[100:103], v[28:31]
    s_waitcnt vmcnt(0) lgkmcnt(3)
    v_mfma_f32_16x16x32_bf16 v[16:19], v[32:35], v[104:107], v[16:19]
    s_waitcnt lgkmcnt(2)
    v_mfma_f32_16x16x32_bf16 v[20:23], v[36:39], v[104:107], v[20:23]
    s_waitcnt lgkmcnt(1)
    v_mfma_f32_16x16x32_bf16 v[24:27], v[40:43], v[104:107], v[24:27]
    s_waitcnt lgkmcnt(0)
    v_mfma_f32_16x16x32_bf16 v[28:31], v[44:47], v[104:107], v[28:31]
    s_lshl_b32 s60, s48, 11
    s_add_u32 s60, s60, 49152
    v_add_u32 v12, s60, v2
    s_xor_b32 s60, s60, 8192
    v_add_u32 v13, s60, v2
    s_cmp_eq_u32 s61, 0
    s_cbranch_scc0 L_ex1_c
    ds_write_b128 v12, v[24:27]
    ds_write_b128 v12, v[28:31] offset:1024
    s_branch L_ex2_c
L_ex1_c:
    ds_write_b128 v12, v[16:19]
    ds_write_b128 v12, v[20:23] offset:1024
    v_mov_b32 v16, v24
    v_mov_b32 v17, v25
    v_mov_b32 v18, v26
    v_mov_b32 v19, v27
    v_mov_b32 v20, v28
    v_mov_b32 v21, v29
    v_mov_b32 v22, v30
    v_mov_b32 v23, v31
L_ex2_c:
    s_waitcnt lgkmcnt(0)
    s_barrier
    ds_read_b128 v[32:35], v13
    ds_read_b128 v[36:39], v13 offset:1024
    v_lshlrev_b32 v40, 16, v112
    v_and_b32 v41, 0xffff0000, v112
    v_lshlrev_b32 v42, 16, v113
    v_and_b32 v43, 0xffff0000, v113
    v_lshlrev_b32 v44, 16, v114
    v_and_b32 v45, 0xffff0000, v114
    v_lshlrev_b32 v46, 16, v115
    v_and_b32 v47, 0xffff0000, v115
    v_add_f32 v16, v16, v40
    v_add_f32 v17, v17, v41
    v_add_f32 v18, v18, v42
    v_add_f32 v19, v19, v43
    v_add_f32 v20, v20, v44
    v_add_f32 v21, v21, v45
    v_add_f32 v22, v22, v46
    v_add_f32 v23, v23, v47
    v_and_b32 v12, 15, v1
    v_lshlrev_b32 v12, 10, v12
    v_and_b32 v13, 1, v8
    v_lshl_add_u32 v12, v13, 5, v12
    v_lshl_add_u32 v12, v9, 4, v12
    s_lshl_b32 s46, s36, 14
    s_lshl_b32 s47, s37, 6
    s_add_u32 s46, s46, s47
    s_waitcnt lgkmcnt(0)
    v_add_f32 v16, v16, v32
    v_add_f32 v17, v17, v33
    v_add_f32 v18, v18, v34
    v_add_f32 v19, v19, v35
    v_add_f32 v20, v20, v36
    v_add_f32 v21, v21, v37
    v_add_f32 v22, v22, v38
    v_add_f32 v23, v23, v39
    v_cvt_pk_bf16_f32 v48, v16, v17
    v_cvt_pk_bf16_f32 v49, v18, v19
    v_cvt_pk_bf16_f32 v50, v20, v21
    v_cvt_pk_bf16_f32 v51, v22, v23
    s_nop 0
    v_permlane16_swap_b32 v48, v50
    v_permlane16_swap_b32 v49, v51
    buffer_store_dwordx4 v[48:51], v12, s[16:19], s46 offen
L_k6_exit:
    s_endpgm
L_kb_loader:
    s_and_b32 s31, s29, 1
    s_lshl_b32 s31, s31, 3
    s_add_u32 s30, s30, s31
    s_mul_i32 s31, s30, 3
    s_min_u32 s31, s31, 40
    s_lshl_b32 s40, s31, 14
    s_lshl_b32 s38, s3, 12
    s_add_u32 s41, s40, s38
    s_add_u32 s41, s41, 21708800
    s_mul_i32 s38, s3, 9216
    s_add_u32 s40, s40, s38
    s_add_u32 s40, s40, 20983808
    s_lshl_b32 s42, s3, 15
    s_add_u32 m0, s42, 24576
    s_mul_i32 s38, s3, 5120
    s_barrier
    buffer_load_dwordx4 v2, s[24:27], s41 offen offset:0 sc1 lds
    buffer_load_dwordx4 v2, s[24:27], s41 offen offset:1024 sc1 lds
    buffer_load_dwordx4 v2, s[24:27], s41 offen offset:2048 sc1 lds
    buffer_load_dwordx4 v2, s[24:27], s41 offen offset:3072 sc1 lds
    s_add_u32 m0, s42, 28672
    s_nop 0
    buffer_load_dwordx4 v2, s[24:27], s40 offen offset:0 sc1 lds
    buffer_load_dwordx4 v2, s[24:27], s40 offen offset:1024 sc1 lds
    buffer_load_dwordx4 v2, s[24:27], s40 offen offset:2048 sc1 lds
    buffer_load_dwordx4 v2, s[24:27], s40 offen offset:3072 sc1 lds
    s_add_u32 m0, s38, 131072
    s_add_u32 s40, s40, 4096
    buffer_load_dwordx4 v2, s[24:27], s40 offen offset:0 sc1 lds
    buffer_load_dwordx4 v2, s[24:27], s40 offen offset:1024 sc1 lds
    buffer_load_dwordx4 v2, s[24:27], s40 offen offset:2048 sc1 lds
    buffer_load_dwordx4 v2, s[24:27], s40 offen offset:3072 sc1 lds
    s_add_u32 m0, s38, 135168
    s_add_u32 s40, s40, 4096
    buffer_load_dwordx4 v2, s[24:27], s40 offen sc1 lds
    s_load_dwordx2 s[16:17], s[0:1], 56
    s_lshl_b32 s35, s56, 6
    s_lshl_b32 s36, s3, 4
    s_add_u32 s35, s35, s36
    v_lshrrev_b32 v12, 3, v1
    v_add_u32 v5, s35, v12
    v_lshlrev_b32 v5, 12, v5
    v_and_b32 v13, 7, v1
    v_lshrrev_b32 v14, 4, v1
    v_xor_b32 v14, v13, v14
    v_lshl_add_u32 v5, v14, 4, v5
    v_xor_b32 v6, 64, v5
    v_add_u32 v6, 32768, v6
    s_lshl_b32 s37, s3, 11
    s_lshl_b32 s36, s57, 2
    s_add_u32 s36, s36, s3
    s_mul_i32 s36, s36, 24576
    s_add_u32 s36, s36, 23068672
    s_mul_i32 s35, s3, 22528
    s_add_u32 s35, s35, 73728
    s_mov_b32 s18, 8388608
    s_mov_b32 s19, 0x00020000
    s_waitcnt vmcnt(0) lgkmcnt(0)
    s_barrier
    s_barrier
    v_mov_b32 v12, 66560
    s_mov_b32 s60, 0
L_ld_kl:
    ds_read_b32 v13, v12
    s_add_u32 s60, s60, 1
    s_waitcnt lgkmcnt(0)
    v_readfirstlane_b32 s43, v13
    s_cmp_gt_u32 s60, 0x400000
    s_cbranch_scc1 L_ld_klok
    s_cmp_ge_u32 s43, 8
    s_cbranch_scc1 L_ld_klok
    s_sleep 2
    s_branch L_ld_kl
L_ld_klok:
    s_add_u32 m0, s37, 0
    s_movk_i32 s41, 0
    buffer_load_dwordx4 v5, s[16:19], s41 offen lds
    s_add_u32 m0, s37, 1024
    s_nop 0
    buffer_load_dwordx4 v6, s[16:19], s41 offen lds
    s_add_u32 m0, s37, 8192
    s_movk_i32 s41, 128
    buffer_load_dwordx4 v5, s[16:19], s41 offen lds
    s_add_u32 m0, s37, 9216
    s_nop 0
    buffer_load_dwordx4 v6, s[16:19], s41 offen lds
    s_barrier
    s_add_u32 m0, s37, 16384
    s_movk_i32 s41, 512
    buffer_load_dwordx4 v5, s[16:19], s41 offen lds
    s_add_u32 m0, s37, 17408
    s_nop 0
    buffer_load_dwordx4 v6, s[16:19], s41 offen lds
    s_add_u32 m0, s37, 24576
    s_movk_i32 s41, 640
    buffer_load_dwordx4 v5, s[16:19], s41 offen lds
    s_add_u32 m0, s37, 25600
    s_nop 0
    buffer_load_dwordx4 v6, s[16:19], s41 offen lds
    s_add_u32 m0, s37, 32768
    s_movk_i32 s41, 1024
    buffer_load_dwordx4 v5, s[16:19], s41 offen lds
    s_add_u32 m0, s37, 33792
    s_nop 0
    buffer_load_dwordx4 v6, s[16:19], s41 offen lds
    s_add_u32 m0, s37, 40960
    s_movk_i32 s41, 1152
    buffer_load_dwordx4 v5, s[16:19], s41 offen lds
    s_add_u32 m0, s37, 41984
    s_nop 0
    buffer_load_dwordx4 v6, s[16:19], s41 offen lds
    s_add_u32 m0, s35, 0
    s_add_u32 s39, s36, 0
    buffer_load_dwordx4 v2, s[24:27], s39 offen sc1 lds
    buffer_load_dwordx4 v2, s[24:27], s39 offen offset:1024 sc1 lds
    s_add_u32 m0, s35, 2048
    s_add_u32 s39, s36, 2048
    buffer_load_dwordx4 v2, s[24:27], s39 offen sc1 lds
    buffer_load_dwordx4 v2, s[24:27], s39 offen offset:1024 sc1 lds
    s_add_u32 m0, s35, 4096
    s_add_u32 s39, s36, 4096
    buffer_load_dwordx4 v2, s[24:27], s39 offen sc1 lds
    buffer_load_dwordx4 v2, s[24:27], s39 offen offset:1024 sc1 lds
    s_add_u32 m0, s35, 6144
    s_add_u32 s39, s36, 6144
    buffer_load_dwordx4 v2, s[24:27], s39 offen sc1 lds
    buffer_load_dwordx4 v2, s[24:27], s39 offen offset:1024 sc1 lds
    s_add_u32 m0, s35, 8192
    s_add_u32 s39, s36, 8192
    buffer_load_dwordx4 v2, s[24:27], s39 offen sc1 lds
    buffer_load_dwordx4 v2, s[24:27], s39 offen offset:1024 sc1 lds
    s_add_u32 m0, s35, 10240
    s_add_u32 s39, s36, 10240
    buffer_load_dwordx4 v2, s[24:27], s39 offen sc1 lds
    buffer_load_dwordx4 v2, s[24:27], s39 offen offset:1024 sc1 lds
    s_add_u32 m0, s35, 12288
    s_add_u32 s39, s36, 12288
    buffer_load_dwordx4 v2, s[24:27], s39 offen sc1 lds
    buffer_load_dwordx4 v2, s[24:27], s39 offen offset:1024 sc1 lds
    s_add_u32 m0, s35, 14336
    s_add_u32 s39, s36, 14336
    buffer_load_dwordx4 v2, s[24:27], s39 offen sc1 lds
    buffer_load_dwordx4 v2, s[24:27], s39 offen offset:1024 sc1 lds
    s_add_u32 m0, s35, 16384
    s_add_u32 s39, s36, 16384
    buffer_load_dwordx4 v2, s[24:27], s39 offen sc1 lds
    buffer_load_dwordx4 v2, s[24:27], s39 offen offset:1024 sc1 lds
    s_add_u32 m0, s35, 18432
    s_add_u32 s39, s36, 18432
    buffer_load_dwordx4 v2, s[24:27], s39 offen sc1 lds
    buffer_load_dwordx4 v2, s[24:27], s39 offen offset:1024 sc1 lds
    s_add_u32 m0, s35, 20480
    s_add_u32 s39, s36, 20480
    buffer_load_dwordx4 v2, s[24:27], s39 offen sc1 lds
    buffer_load_dwordx4 v2, s[24:27], s39 offen offset:1024 sc1 lds
    s_barrier
    s_waitcnt vmcnt(30)
    s_barrier
    s_waitcnt vmcnt(26)
    s_barrier
    s_add_u32 m0, s37, 0
    s_movk_i32 s41, 1536
    buffer_load_dwordx4 v5, s[16:19], s41 offen lds
    s_add_u32 m0, s37, 1024
    s_nop 0
    buffer_load_dwordx4 v6, s[16:19], s41 offen lds
    s_add_u32 m0, s37, 8192
    s_movk_i32 s41, 1664
    buffer_load_dwordx4 v5, s[16:19], s41 offen lds
    s_add_u32 m0, s37, 9216
    s_nop 0
    buffer_load_dwordx4 v6, s[16:19], s41 offen lds
    s_waitcnt vmcnt(26)
    s_barrier
    s_add_u32 m0, s37, 16384
    s_movk_i32 s41, 2048
    buffer_load_dwordx4 v5, s[16:19], s41 offen lds
    s_add_u32 m0, s37, 17408
    s_nop 0
    buffer_load_dwordx4 v6, s[16:19], s41 offen lds
    s_add_u32 m0, s37, 24576
    s_movk_i32 s41, 2176
    buffer_load_dwordx4 v5, s[16:19], s41 offen lds
    s_add_u32 m0, s37, 25600
    s_nop 0
    buffer_load_dwordx4 v6, s[16:19], s41 offen lds
    s_waitcnt vmcnt(4)
    s_barrier
    s_add_u32 m0, s37, 32768
    s_movk_i32 s41, 2560
    buffer_load_dwordx4 v5, s[16:19], s41 offen lds
    s_add_u32 m0, s37, 33792
    s_nop 0
    buffer_load_dwordx4 v6, s[16:19], s41 offen lds
    s_add_u32 m0, s37, 40960
    s_movk_i32 s41, 2688
    buffer_load_dwordx4 v5, s[16:19], s41 offen lds
    s_add_u32 m0, s37, 41984
    s_nop 0
    buffer_load_dwordx4 v6, s[16:19], s41 offen lds
    s_waitcnt vmcnt(4)
    s_barrier
    s_add_u32 m0, s37, 0
    s_movk_i32 s41, 3072
    buffer_load_dwordx4 v5, s[16:19], s41 offen lds
    s_add_u32 m0, s37, 1024
    s_nop 0
    buffer_load_dwordx4 v6, s[16:19], s41 offen lds
    s_add_u32 m0, s37, 8192
    s_movk_i32 s41, 3200
    buffer_load_dwordx4 v5, s[16:19], s41 offen lds
    s_add_u32 m0, s37, 9216
    s_nop 0
    buffer_load_dwordx4 v6, s[16:19], s41 offen lds
    s_waitcnt vmcnt(4)
    s_barrier
    s_add_u32 m0, s37, 16384
    s_movk_i32 s41, 3584
    buffer_load_dwordx4 v5, s[16:19], s41 offen lds
    s_add_u32 m0, s37, 17408
    s_nop 0
    buffer_load_dwordx4 v6, s[16:19], s41 offen lds
    s_add_u32 m0, s37, 24576
    s_movk_i32 s41, 3712
    buffer_load_dwordx4 v5, s[16:19], s41 offen lds
    s_add_u32 m0, s37, 25600
    s_nop 0
    buffer_load_dwordx4 v6, s[16:19], s41 offen lds
    s_waitcnt vmcnt(4)
    s_barrier
    s_add_u32 m0, s37, 32768
    s_movk_i32 s41, 256
    buffer_load_dwordx4 v5, s[16:19], s41 offen lds
    s_add_u32 m0, s37, 33792
    s_nop 0
    buffer_load_dwordx4 v6, s[16:19], s41 offen lds
    s_add_u32 m0, s37, 40960
    s_movk_i32 s41, 384
    buffer_load_dwordx4 v5, s[16:19], s41 offen lds
    s_add_u32 m0, s37, 41984
    s_nop 0
    buffer_load_dwordx4 v6, s[16:19], s41 offen lds
    s_waitcnt vmcnt(4)
    s_barrier
    s_add_u32 m0, s37, 0
    s_movk_i32 s41, 768
    buffer_load_dwordx4 v5, s[16:19], s41 offen lds
    s_add_u32 m0, s37, 1024
    s_nop 0
    buffer_load_dwordx4 v6, s[16:19], s41 offen lds
    s_add_u32 m0, s37, 8192
    s_movk_i32 s41, 896
    buffer_load_dwordx4 v5, s[16:19], s41 offen lds
    s_add_u32 m0, s37, 9216
    s_nop 0
    buffer_load_dwordx4 v6, s[16:19], s41 offen lds
    s_waitcnt vmcnt(4)
    s_barrier
    s_add_u32 m0, s37, 16384
    s_movk_i32 s41, 1280
    buffer_load_dwordx4 v5, s[16:19], s41 offen lds
    s_add_u32 m0, s37, 17408
    s_nop 0
    buffer_load_dwordx4 v6, s[16:19], s41 offen lds
    s_add_u32 m0, s37, 24576
    s_movk_i32 s41, 1408
    buffer_load_dwordx4 v5, s[16:19], s41 offen lds
    s_add_u32 m0, s37, 25600
    s_nop 0
    buffer_load_dwordx4 v6, s[16:19], s41 offen lds
    s_waitcnt vmcnt(4)
    s_barrier
    s_add_u32 m0, s37, 32768
    s_movk_i32 s41, 1792
    buffer_load_dwordx4 v5, s[16:19], s41 offen lds
    s_add_u32 m0, s37, 33792
    s_nop 0
    buffer_load_dwordx4 v6, s[16:19], s41 offen lds
    s_add_u32 m0, s37, 40960
    s_movk_i32 s41, 1920
    buffer_load_dwordx4 v5, s[16:19], s41 offen lds
    s_add_u32 m0, s37, 41984
    s_nop 0
    buffer_load_dwordx4 v6, s[16:19], s41 offen lds
    s_waitcnt vmcnt(4)
    s_barrier
    s_add_u32 m0, s37, 0
    s_movk_i32 s41, 2304
    buffer_load_dwordx4 v5, s[16:19], s41 offen lds
    s_add_u32 m0, s37, 1024
    s_nop 0
    buffer_load_dwordx4 v6, s[16:19], s41 offen lds
    s_add_u32 m0, s37, 8192
    s_movk_i32 s41, 2432
    buffer_load_dwordx4 v5, s[16:19], s41 offen lds
    s_add_u32 m0, s37, 9216
    s_nop 0
    buffer_load_dwordx4 v6, s[16:19], s41 offen lds
    s_waitcnt vmcnt(4)
    s_barrier
    s_add_u32 m0, s37, 16384
    s_movk_i32 s41, 2816
    buffer_load_dwordx4 v5, s[16:19], s41 offen lds
    s_add_u32 m0, s37, 17408
    s_nop 0
    buffer_load_dwordx4 v6, s[16:19], s41 offen lds
    s_add_u32 m0, s37, 24576
    s_movk_i32 s41, 2944
    buffer_load_dwordx4 v5, s[16:19], s41 offen lds
    s_add_u32 m0, s37, 25600
    s_nop 0
    buffer_load_dwordx4 v6, s[16:19], s41 offen lds
    s_waitcnt vmcnt(4)
    s_barrier
    s_add_u32 m0, s37, 32768
    s_movk_i32 s41, 3328
    buffer_load_dwordx4 v5, s[16:19], s41 offen lds
    s_add_u32 m0, s37, 33792
    s_nop 0
    buffer_load_dwordx4 v6, s[16:19], s41 offen lds
    s_add_u32 m0, s37, 40960
    s_movk_i32 s41, 3456
    buffer_load_dwordx4 v5, s[16:19], s41 offen lds
    s_add_u32 m0, s37, 41984
    s_nop 0
    buffer_load_dwordx4 v6, s[16:19], s41 offen lds
    s_waitcnt vmcnt(4)
    s_barrier
    s_add_u32 m0, s37, 0
    s_movk_i32 s41, 3840
    buffer_load_dwordx4 v5, s[16:19], s41 offen lds
    s_add_u32 m0, s37, 1024
    s_nop 0
    buffer_load_dwordx4 v6, s[16:19], s41 offen lds
    s_add_u32 m0, s37, 8192
    s_movk_i32 s41, 3968
    buffer_load_dwordx4 v5, s[16:19], s41 offen lds
    s_add_u32 m0, s37, 9216
    s_nop 0
    buffer_load_dwordx4 v6, s[16:19], s41 offen lds
    s_waitcnt vmcnt(4)
    s_barrier
    s_waitcnt vmcnt(0)
    s_barrier
    s_branch L_k6
L_sequential_preLN__grouped_kv_mqa__mixer_gmlp__prompt_kernel_end:
    s_endpgm
.section .rodata,"a"
.p2align 6
.amdhsa_kernel sequential_preLN__grouped_kv_mqa__mixer_gmlp__prompt_kernel
  .amdhsa_next_free_vgpr 128
  .amdhsa_next_free_sgpr 96
  .amdhsa_accum_offset 128
  .amdhsa_group_segment_fixed_size 0
  .amdhsa_kernarg_size 104
  .amdhsa_user_sgpr_count 2
  .amdhsa_user_sgpr_kernarg_segment_ptr 1
  .amdhsa_system_sgpr_workgroup_id_x 1
.end_amdhsa_kernel
```
